```python
import torch

def _softmax(x, axis=-1):
    return torch.softmax(x, dim=axis)
def _gelu(x):
    return torch.nn.functional.gelu(x, approximate="tanh")
def _silu(x):
    return torch.nn.functional.silu(x)
def _sigmoid(x):
    return torch.sigmoid(x)
def _layernorm(x, axis=-1, eps=1e-5):
    m = x.mean(dim=axis, keepdim=True)
    v = x.var(dim=axis, keepdim=True, unbiased=False)
    return (x - m) / torch.sqrt(v + eps)
def _scatter_add(tgt, idx, src, axis=0):
    return tgt.clone().index_add_(axis, idx, src)
def _segment_sum(src, seg, n):
    out = torch.zeros((n,) + src.shape[1:], dtype=src.dtype)
    return out.index_add_(0, seg, src)
def _pad(x, pw):
    flat = tuple(v for pair in reversed(pw) for v in pair)
    return torch.nn.functional.pad(x, flat)

kernel_name = 'sequential_preLN__gqa_block_cached__swiglu_ffn__decode'

def setup_inputs():

    _w = (lambda a: (lambda t: t.to(torch.bfloat16) if t.is_floating_point() else t)(torch.as_tensor(a)))
    def _A_setup():
        B, Sq, D = 2, 1, 512
        Hq, Hkv, Sk, Dh = 32, 8, 8192, 128
        assert Hq % Hkv == 0, (Hq, Hkv)
        return {
            "x": _w((lambda *s: torch.randn(*s, dtype=torch.bfloat16) * 0.05)(B, Sq, D)),
            "k_cache": _w((lambda *s: torch.randn(*s, dtype=torch.bfloat16) * 3.2)(B, Hkv, Sk, Dh)),
            "v_cache": _w((lambda *s: torch.randn(*s, dtype=torch.bfloat16) * 0.4)(B, Hkv, Sk, Dh)),
            "wq": _w((lambda *s: torch.randn(*s, dtype=torch.bfloat16) * 3.2)(D, Hq * Dh) * (D ** -0.5)),
            "wo": _w((lambda *s: torch.randn(*s, dtype=torch.bfloat16) * 0.4)(Hq * Dh, D) * ((Hq * Dh) ** -0.5)),
        }
    _A_in = _A_setup()

    def _B_setup():
        B, S, D, F = 2, 1, 512, 1792
        return {
            "x": _w((lambda *s: torch.randn(*s, dtype=torch.bfloat16) * 0.05)(B, S, D)),
            "w_gate": _w((lambda *s: torch.randn(*s, dtype=torch.bfloat16) * 0.05)(D, F)),
            "w_up": _w((lambda *s: torch.randn(*s, dtype=torch.bfloat16) * 0.05)(D, F)),
            "w_down": _w((lambda *s: torch.randn(*s, dtype=torch.bfloat16) * 0.05)(F, D)),
        }
    _B_in = _B_setup()

    return {
        "A_x": _A_in["x"],
        "A_k_cache": _A_in["k_cache"],
        "A_v_cache": _A_in["v_cache"],
        "A_wq": _A_in["wq"],
        "A_wo": _A_in["wo"],
        "B_x": _B_in["x"],
        "B_w_gate": _B_in["w_gate"],
        "B_w_up": _B_in["w_up"],
        "B_w_down": _B_in["w_down"],
    }

def reference(A_x, A_k_cache, A_v_cache, A_wq, A_wo, B_x, B_w_gate, B_w_up, B_w_down):
    def _A_ref(x, k_cache, v_cache, wq, wo):
        B, Sq, D = x.shape
        Hq, Dh = 32, 128
        Hkv = k_cache.shape[1]
        rep = Hq // Hkv
        q = (lambda x, *d: x.permute(*d))((x @ wq).reshape(B, Sq, Hq, Dh), 0, 2, 1, 3)
        k = (lambda x, n, axis: torch.repeat_interleave(x, n, dim=axis))(k_cache, rep, axis=1)
        v = (lambda x, n, axis: torch.repeat_interleave(x, n, dim=axis))(v_cache, rep, axis=1)
        scores = torch.einsum("bhqd,bhkd->bhqk", q, k) * (Dh ** -0.5)
        p = _softmax(scores, axis=-1)
        o = torch.einsum("bhqk,bhkd->bhqd", p, v)
        return (lambda x, *d: x.permute(*d))(o, 0, 2, 1, 3).reshape(B, Sq, Hq * Dh) @ wo

    def _B_ref(x, w_gate, w_up, w_down):
        g = _silu(x @ w_gate)
        u = x @ w_up
        return (g * u) @ w_down

    x = A_x
    h = x + _A_ref(_layernorm(x, axis=-1), A_k_cache, A_v_cache, A_wq, A_wo)
    h2 = h + _B_ref(_layernorm(h, axis=-1), B_w_gate, B_w_up, B_w_down)
    return h2
```

```asm
; @launch grid=(256,1,1) block=(576,1,1) lds=131072
.amdgcn_target "amdgcn-amd-amdhsa--gfx950"
.text
.globl sequential_preLN__gqa_block_cached__swiglu_ffn__decode_kernel
.p2align 8
.type sequential_preLN__gqa_block_cached__swiglu_ffn__decode_kernel,@function
sequential_preLN__gqa_block_cached__swiglu_ffn__decode_kernel:
  s_cmp_ge_u32 s2, 256
  s_cbranch_scc1 L_end2
  s_load_dwordx16 s[4:19], s[0:1], 0
  s_load_dwordx8 s[20:27], s[0:1], 64
  v_lshrrev_b32 v1, 6, v0
  v_and_b32 v0, 63, v0
  s_nop 0
  v_readfirstlane_b32 s28, v1
  s_and_b32 s58, s2, 7
  s_bfe_u32 s29, s2, 0x30004
  s_lshr_b32 s30, s2, 7
  s_and_b32 s31, s2, 15
  s_lshr_b32 s32, s2, 4
  s_mov_b32 s44, 0x3fb8aa3b
  s_mov_b32 s45, 0x3db504f3
  s_and_b32 s33, s31, 7
  s_lshl_b32 s33, s33, 1
  s_lshr_b32 s34, s31, 3
  s_or_b32 s59, s33, s34
  s_bfe_u32 s33, s2, 0x20004
  s_lshl_b32 s33, s33, 3
  s_add_u32 s33, s33, s58
  s_bfe_u32 s34, s2, 0x10003
  s_lshl_b32 s50, s33, 6
  s_lshl_b32 s34, s34, 5
  s_add_u32 s50, s50, s34
  s_mov_b32 s51, 0
  s_cmp_lt_u32 s33, 28
  s_cselect_b32 s51, 1, 0
  s_cmp_lt_u32 s2, 64
  s_cselect_b32 s51, s51, 0
  s_bfe_u32 s34, s2, 0x20003
  s_lshl_b32 s34, s34, 4
  s_lshl_b32 s33, s58, 6
  s_add_u32 s33, s33, s34
  s_lshr_b32 s34, s2, 5
  s_cmp_eq_u32 s34, 2
  s_cselect_b32 s51, 2, s51
  s_cselect_b32 s50, s33, s50
  s_waitcnt lgkmcnt(0)
  s_cmp_eq_u32 s28, 8
  s_cbranch_scc1 L_ctrl
  s_lshl_b32 s33, s32, 21
  s_lshl_b32 s34, s31, 17
  s_add_u32 s33, s33, s34
  s_lshl_b32 s34, s28, 14
  s_add_u32 s33, s33, s34
  v_lshrrev_b32 v1, 4, v0
  v_bfe_u32 v2, v0, 2, 2
  v_and_b32 v3, 3, v0
  v_lshlrev_b32 v9, 6, v1
  v_lshlrev_b32 v10, 8, v2
  v_lshlrev_b32 v11, 4, v3
  v_add3_u32 v9, v9, v10, v11
  v_add_u32 v4, s33, v9
  v_lshlrev_b32 v9, 4, v0
  v_add_u32 v5, s33, v9
  v_mov_b32 v6, 0xffff
  v_mov_b32 v7, 0xffff0000
  s_lshl_b32 s33, s29, 19
  s_lshl_b32 s34, s28, 16
  s_add_u32 s33, s33, s34
  s_lshl_b32 s34, s59, 6
  s_add_u32 s33, s33, s34
  v_lshrrev_b32 v9, 2, v0
  v_lshlrev_b32 v9, 10, v9
  v_lshlrev_b32 v10, 4, v3
  v_add3_u32 v8, v9, v10, s33
  s_lshl_b32 s35, s28, 12
  s_add_u32 s35, s35, 32768
  v_mov_b32 v164, 0
  s_mov_b32 s49, 1
  s_getpc_b64 s[56:57]
L_pc0:
  s_add_u32 s56, s56, L_qk-L_pc0
  s_addc_u32 s57, s57, 0
  global_load_dwordx4 v[20:23], v4, s[6:7] offset:0 nt
  global_load_dwordx4 v[24:27], v4, s[6:7] offset:1024 nt
  global_load_dwordx4 v[28:31], v4, s[6:7] offset:2048 nt
  s_barrier
  s_waitcnt vmcnt(2)
  global_load_dwordx4 v[32:35], v4, s[6:7] offset:3072 nt
  s_waitcnt vmcnt(2)
  v_add_u32 v4, 4096, v4
  global_load_dwordx4 v[36:39], v4, s[6:7] offset:0 nt
  s_waitcnt vmcnt(2)
  global_load_dwordx4 v[40:43], v4, s[6:7] offset:1024 nt
  s_waitcnt vmcnt(2)
  global_load_dwordx4 v[44:47], v4, s[6:7] offset:2048 nt
  s_waitcnt vmcnt(2)
  global_load_dwordx4 v[48:51], v4, s[6:7] offset:3072 nt
  s_waitcnt vmcnt(2)
  v_add_u32 v4, 4096, v4
  global_load_dwordx4 v[52:55], v4, s[6:7] offset:0 nt
  s_waitcnt vmcnt(2)
  global_load_dwordx4 v[56:59], v4, s[6:7] offset:1024 nt
  s_waitcnt vmcnt(2)
  global_load_dwordx4 v[60:63], v4, s[6:7] offset:2048 nt
  s_waitcnt vmcnt(2)
  global_load_dwordx4 v[64:67], v4, s[6:7] offset:3072 nt
  s_waitcnt vmcnt(2)
  v_add_u32 v4, 4096, v4
  global_load_dwordx4 v[68:71], v4, s[6:7] offset:0 nt
  s_waitcnt vmcnt(2)
  global_load_dwordx4 v[72:75], v4, s[6:7] offset:1024 nt
  s_waitcnt vmcnt(2)
  global_load_dwordx4 v[76:79], v4, s[6:7] offset:2048 nt
  s_waitcnt vmcnt(2)
  global_load_dwordx4 v[80:83], v4, s[6:7] offset:3072 nt
  s_waitcnt vmcnt(2)
  global_load_dwordx4 v[84:87], v5, s[8:9] offset:0 nt
  s_waitcnt vmcnt(2)
  global_load_dwordx4 v[88:91], v5, s[8:9] offset:1024 nt
  s_waitcnt vmcnt(2)
  global_load_dwordx4 v[92:95], v5, s[8:9] offset:2048 nt
  s_waitcnt vmcnt(3)
  ds_read_b32 v165, v164 offset:5504
  s_waitcnt lgkmcnt(0)
  v_readfirstlane_b32 s48, v165
  s_cmp_eq_u32 s48, s49
  s_cbranch_scc0 L_nocall_1
  s_swappc_b64 s[54:55], s[56:57]
L_nocall_1:
  s_waitcnt vmcnt(2)
  global_load_dwordx4 v[96:99], v5, s[8:9] offset:3072 nt
  ds_read_b32 v165, v164 offset:5504
  s_waitcnt lgkmcnt(0)
  v_readfirstlane_b32 s48, v165
  s_cmp_eq_u32 s48, s49
  s_cbranch_scc0 L_nocall_2
  s_swappc_b64 s[54:55], s[56:57]
L_nocall_2:
  s_waitcnt vmcnt(2)
  v_add_u32 v5, 4096, v5
  global_load_dwordx4 v[100:103], v5, s[8:9] offset:0 nt
  ds_read_b32 v165, v164 offset:5504
  s_waitcnt lgkmcnt(0)
  v_readfirstlane_b32 s48, v165
  s_cmp_eq_u32 s48, s49
  s_cbranch_scc0 L_nocall_3
  s_swappc_b64 s[54:55], s[56:57]
L_nocall_3:
  s_waitcnt vmcnt(2)
  global_load_dwordx4 v[104:107], v5, s[8:9] offset:1024 nt
  ds_read_b32 v165, v164 offset:5504
  s_waitcnt lgkmcnt(0)
  v_readfirstlane_b32 s48, v165
  s_cmp_eq_u32 s48, s49
  s_cbranch_scc0 L_nocall_4
  s_swappc_b64 s[54:55], s[56:57]
L_nocall_4:
  s_waitcnt vmcnt(2)
  global_load_dwordx4 v[108:111], v5, s[8:9] offset:2048 nt
  ds_read_b32 v165, v164 offset:5504
  s_waitcnt lgkmcnt(0)
  v_readfirstlane_b32 s48, v165
  s_cmp_eq_u32 s48, s49
  s_cbranch_scc0 L_nocall_5
  s_swappc_b64 s[54:55], s[56:57]
L_nocall_5:
  s_waitcnt vmcnt(2)
  global_load_dwordx4 v[112:115], v5, s[8:9] offset:3072 nt
  ds_read_b32 v165, v164 offset:5504
  s_waitcnt lgkmcnt(0)
  v_readfirstlane_b32 s48, v165
  s_cmp_eq_u32 s48, s49
  s_cbranch_scc0 L_nocall_6
  s_swappc_b64 s[54:55], s[56:57]
L_nocall_6:
  s_waitcnt vmcnt(7)
  v_add_u32 v5, 4096, v5
  global_load_dwordx4 v[116:119], v5, s[8:9] offset:0 nt
  ds_read_b32 v165, v164 offset:5504
  s_waitcnt lgkmcnt(0)
  v_readfirstlane_b32 s48, v165
  s_cmp_eq_u32 s48, s49
  s_cbranch_scc0 L_nocall_7
  s_swappc_b64 s[54:55], s[56:57]
L_nocall_7:
  s_waitcnt vmcnt(7)
  global_load_dwordx4 v[120:123], v5, s[8:9] offset:1024 nt
  ds_read_b32 v165, v164 offset:5504
  s_waitcnt lgkmcnt(0)
  v_readfirstlane_b32 s48, v165
  s_cmp_eq_u32 s48, s49
  s_cbranch_scc0 L_nocall_8
  s_swappc_b64 s[54:55], s[56:57]
L_nocall_8:
  s_waitcnt vmcnt(7)
  global_load_dwordx4 v[124:127], v5, s[8:9] offset:2048 nt
  ds_read_b32 v165, v164 offset:5504
  s_waitcnt lgkmcnt(0)
  v_readfirstlane_b32 s48, v165
  s_cmp_eq_u32 s48, s49
  s_cbranch_scc0 L_nocall_9
  s_swappc_b64 s[54:55], s[56:57]
L_nocall_9:
  s_waitcnt vmcnt(7)
  global_load_dwordx4 v[128:131], v5, s[8:9] offset:3072 nt
  ds_read_b32 v165, v164 offset:5504
  s_waitcnt lgkmcnt(0)
  v_readfirstlane_b32 s48, v165
  s_cmp_eq_u32 s48, s49
  s_cbranch_scc0 L_nocall_10
  s_swappc_b64 s[54:55], s[56:57]
L_nocall_10:
  s_waitcnt vmcnt(7)
  v_add_u32 v5, 4096, v5
  global_load_dwordx4 v[132:135], v5, s[8:9] offset:0 nt
  ds_read_b32 v165, v164 offset:5504
  s_waitcnt lgkmcnt(0)
  v_readfirstlane_b32 s48, v165
  s_cmp_eq_u32 s48, s49
  s_cbranch_scc0 L_nocall_11
  s_swappc_b64 s[54:55], s[56:57]
L_nocall_11:
  s_waitcnt vmcnt(7)
  global_load_dwordx4 v[136:139], v5, s[8:9] offset:1024 nt
  ds_read_b32 v165, v164 offset:5504
  s_waitcnt lgkmcnt(0)
  v_readfirstlane_b32 s48, v165
  s_cmp_eq_u32 s48, s49
  s_cbranch_scc0 L_nocall_12
  s_swappc_b64 s[54:55], s[56:57]
L_nocall_12:
  s_waitcnt vmcnt(7)
  global_load_dwordx4 v[140:143], v5, s[8:9] offset:2048 nt
  ds_read_b32 v165, v164 offset:5504
  s_waitcnt lgkmcnt(0)
  v_readfirstlane_b32 s48, v165
  s_cmp_eq_u32 s48, s49
  s_cbranch_scc0 L_nocall_13
  s_swappc_b64 s[54:55], s[56:57]
L_nocall_13:
  s_waitcnt vmcnt(7)
  global_load_dwordx4 v[144:147], v5, s[8:9] offset:3072 nt
  ds_read_b32 v165, v164 offset:5504
  s_waitcnt lgkmcnt(0)
  v_readfirstlane_b32 s48, v165
  s_cmp_eq_u32 s48, s49
  s_cbranch_scc0 L_nocall_14
  s_swappc_b64 s[54:55], s[56:57]
L_nocall_14:
  s_mov_b32 s46, 64000
L_wq_15:
  s_cmp_eq_u32 s49, 2
  s_cbranch_scc1 L_wq_done_16
  ds_read_b32 v165, v164 offset:5504
  s_waitcnt lgkmcnt(0)
  v_readfirstlane_b32 s48, v165
  s_cmp_eq_u32 s48, s49
  s_cbranch_scc0 L_nocall_17
  s_swappc_b64 s[54:55], s[56:57]
L_nocall_17:
  s_sub_u32 s46, s46, 1
  s_cmp_lg_u32 s46, 0
  s_cbranch_scc1 L_wq_15
L_wq_done_16:
  v_mov_b32 v16, 0
  v_mov_b32 v17, 0
  v_mov_b32 v18, 0
  v_mov_b32 v19, 0
  v_mov_b32 v20, 0
  v_mov_b32 v21, 0
  v_mov_b32 v22, 0
  v_mov_b32 v23, 0
  v_mov_b32 v24, 0
  v_mov_b32 v25, 0
  v_mov_b32 v26, 0
  v_mov_b32 v27, 0
  v_mov_b32 v28, 0
  v_mov_b32 v29, 0
  v_mov_b32 v30, 0
  v_mov_b32 v31, 0
  v_mov_b32 v32, 0
  v_mov_b32 v33, 0
  v_mov_b32 v34, 0
  v_mov_b32 v35, 0
  v_mov_b32 v36, 0
  v_mov_b32 v37, 0
  v_mov_b32 v38, 0
  v_mov_b32 v39, 0
  v_mov_b32 v40, 0
  v_mov_b32 v41, 0
  v_mov_b32 v42, 0
  v_mov_b32 v43, 0
  v_mov_b32 v44, 0
  v_mov_b32 v45, 0
  v_mov_b32 v46, 0
  v_mov_b32 v47, 0
  v_mov_b32 v48, 0
  v_mov_b32 v49, 0
  v_mov_b32 v50, 0
  v_mov_b32 v51, 0
  v_mov_b32 v52, 0
  v_mov_b32 v53, 0
  v_mov_b32 v54, 0
  v_mov_b32 v55, 0
  v_mov_b32 v56, 0
  v_mov_b32 v57, 0
  v_mov_b32 v58, 0
  v_mov_b32 v59, 0
  v_mov_b32 v60, 0
  v_mov_b32 v61, 0
  v_mov_b32 v62, 0
  v_mov_b32 v63, 0
  v_mov_b32 v64, 0
  v_mov_b32 v65, 0
  v_mov_b32 v66, 0
  v_mov_b32 v67, 0
  v_mov_b32 v68, 0
  v_mov_b32 v69, 0
  v_mov_b32 v70, 0
  v_mov_b32 v71, 0
  v_mov_b32 v72, 0
  v_mov_b32 v73, 0
  v_mov_b32 v74, 0
  v_mov_b32 v75, 0
  v_mov_b32 v76, 0
  v_mov_b32 v77, 0
  v_mov_b32 v78, 0
  v_mov_b32 v79, 0
  v_mov_b32 v80, 0
  v_mov_b32 v81, 0
  v_lshlrev_b32 v9, 3, v3
  s_mov_b32 s46, 64000
L_wg_18:
  ds_read_b32 v165, v164 offset:5512
  s_waitcnt lgkmcnt(0)
  v_readfirstlane_b32 s48, v165
  s_cmp_eq_u32 s48, 1
  s_cbranch_scc1 L_wg_done_19
  s_sub_u32 s46, s46, 1
  s_cmp_lg_u32 s46, 0
  s_cbranch_scc1 L_wg_18
L_wg_done_19:
  ds_read_b64 v[12:13], v9 offset:5376
  s_waitcnt lgkmcnt(0)
  v_sub_f32 v152, v152, v12
  v_mul_f32 v152, s44, v152
  v_exp_f32 v152, v152
  v_sub_f32 v153, v153, v12
  v_mul_f32 v153, s44, v153
  v_exp_f32 v153, v153
  v_sub_f32 v154, v154, v12
  v_mul_f32 v154, s44, v154
  v_exp_f32 v154, v154
  v_sub_f32 v155, v155, v12
  v_mul_f32 v155, s44, v155
  v_exp_f32 v155, v155
  s_nop 0
  v_mul_f32 v152, v152, v13
  v_cvt_pk_bf16_f32 v152, v152, v152
  v_mul_f32 v153, v153, v13
  v_cvt_pk_bf16_f32 v153, v153, v153
  v_mul_f32 v154, v154, v13
  v_cvt_pk_bf16_f32 v154, v154, v154
  v_mul_f32 v155, v155, v13
  v_cvt_pk_bf16_f32 v155, v155, v155
  s_nop 1
  v_and_b32_dpp v18, v152, v6 quad_perm:[0,1,2,3] row_mask:0xf bank_mask:0x1
  v_and_b32_dpp v18, v152, v7 row_ror:4 row_mask:0xf bank_mask:0x2
  v_and_b32_dpp v19, v152, v6 row_ror:8 row_mask:0xf bank_mask:0x4
  v_and_b32_dpp v19, v152, v7 row_ror:12 row_mask:0xf bank_mask:0x8
  v_and_b32_dpp v22, v152, v6 row_ror:12 row_mask:0xf bank_mask:0x1
  v_and_b32_dpp v22, v152, v7 quad_perm:[0,1,2,3] row_mask:0xf bank_mask:0x2
  v_and_b32_dpp v23, v152, v6 row_ror:4 row_mask:0xf bank_mask:0x4
  v_and_b32_dpp v23, v152, v7 row_ror:8 row_mask:0xf bank_mask:0x8
  v_and_b32_dpp v26, v152, v6 row_ror:8 row_mask:0xf bank_mask:0x1
  v_and_b32_dpp v26, v152, v7 row_ror:12 row_mask:0xf bank_mask:0x2
  v_and_b32_dpp v27, v152, v6 quad_perm:[0,1,2,3] row_mask:0xf bank_mask:0x4
  v_and_b32_dpp v27, v152, v7 row_ror:4 row_mask:0xf bank_mask:0x8
  v_and_b32_dpp v30, v152, v6 row_ror:4 row_mask:0xf bank_mask:0x1
  v_and_b32_dpp v30, v152, v7 row_ror:8 row_mask:0xf bank_mask:0x2
  v_and_b32_dpp v31, v152, v6 row_ror:12 row_mask:0xf bank_mask:0x4
  v_and_b32_dpp v31, v152, v7 quad_perm:[0,1,2,3] row_mask:0xf bank_mask:0x8
  v_and_b32_dpp v34, v153, v6 quad_perm:[0,1,2,3] row_mask:0xf bank_mask:0x1
  v_and_b32_dpp v34, v153, v7 row_ror:4 row_mask:0xf bank_mask:0x2
  v_and_b32_dpp v35, v153, v6 row_ror:8 row_mask:0xf bank_mask:0x4
  v_and_b32_dpp v35, v153, v7 row_ror:12 row_mask:0xf bank_mask:0x8
  v_and_b32_dpp v38, v153, v6 row_ror:12 row_mask:0xf bank_mask:0x1
  v_and_b32_dpp v38, v153, v7 quad_perm:[0,1,2,3] row_mask:0xf bank_mask:0x2
  v_and_b32_dpp v39, v153, v6 row_ror:4 row_mask:0xf bank_mask:0x4
  v_and_b32_dpp v39, v153, v7 row_ror:8 row_mask:0xf bank_mask:0x8
  v_and_b32_dpp v42, v153, v6 row_ror:8 row_mask:0xf bank_mask:0x1
  v_and_b32_dpp v42, v153, v7 row_ror:12 row_mask:0xf bank_mask:0x2
  v_and_b32_dpp v43, v153, v6 quad_perm:[0,1,2,3] row_mask:0xf bank_mask:0x4
  v_and_b32_dpp v43, v153, v7 row_ror:4 row_mask:0xf bank_mask:0x8
  v_and_b32_dpp v46, v153, v6 row_ror:4 row_mask:0xf bank_mask:0x1
  v_and_b32_dpp v46, v153, v7 row_ror:8 row_mask:0xf bank_mask:0x2
  v_and_b32_dpp v47, v153, v6 row_ror:12 row_mask:0xf bank_mask:0x4
  v_and_b32_dpp v47, v153, v7 quad_perm:[0,1,2,3] row_mask:0xf bank_mask:0x8
  v_and_b32_dpp v50, v154, v6 quad_perm:[0,1,2,3] row_mask:0xf bank_mask:0x1
  v_and_b32_dpp v50, v154, v7 row_ror:4 row_mask:0xf bank_mask:0x2
  v_and_b32_dpp v51, v154, v6 row_ror:8 row_mask:0xf bank_mask:0x4
  v_and_b32_dpp v51, v154, v7 row_ror:12 row_mask:0xf bank_mask:0x8
  v_and_b32_dpp v54, v154, v6 row_ror:12 row_mask:0xf bank_mask:0x1
  v_and_b32_dpp v54, v154, v7 quad_perm:[0,1,2,3] row_mask:0xf bank_mask:0x2
  v_and_b32_dpp v55, v154, v6 row_ror:4 row_mask:0xf bank_mask:0x4
  v_and_b32_dpp v55, v154, v7 row_ror:8 row_mask:0xf bank_mask:0x8
  v_and_b32_dpp v58, v154, v6 row_ror:8 row_mask:0xf bank_mask:0x1
  v_and_b32_dpp v58, v154, v7 row_ror:12 row_mask:0xf bank_mask:0x2
  v_and_b32_dpp v59, v154, v6 quad_perm:[0,1,2,3] row_mask:0xf bank_mask:0x4
  v_and_b32_dpp v59, v154, v7 row_ror:4 row_mask:0xf bank_mask:0x8
  v_and_b32_dpp v62, v154, v6 row_ror:4 row_mask:0xf bank_mask:0x1
  v_and_b32_dpp v62, v154, v7 row_ror:8 row_mask:0xf bank_mask:0x2
  v_and_b32_dpp v63, v154, v6 row_ror:12 row_mask:0xf bank_mask:0x4
  v_and_b32_dpp v63, v154, v7 quad_perm:[0,1,2,3] row_mask:0xf bank_mask:0x8
  v_and_b32_dpp v66, v155, v6 quad_perm:[0,1,2,3] row_mask:0xf bank_mask:0x1
  v_and_b32_dpp v66, v155, v7 row_ror:4 row_mask:0xf bank_mask:0x2
  v_and_b32_dpp v67, v155, v6 row_ror:8 row_mask:0xf bank_mask:0x4
  v_and_b32_dpp v67, v155, v7 row_ror:12 row_mask:0xf bank_mask:0x8
  v_and_b32_dpp v70, v155, v6 row_ror:12 row_mask:0xf bank_mask:0x1
  v_and_b32_dpp v70, v155, v7 quad_perm:[0,1,2,3] row_mask:0xf bank_mask:0x2
  v_and_b32_dpp v71, v155, v6 row_ror:4 row_mask:0xf bank_mask:0x4
  v_and_b32_dpp v71, v155, v7 row_ror:8 row_mask:0xf bank_mask:0x8
  v_and_b32_dpp v74, v155, v6 row_ror:8 row_mask:0xf bank_mask:0x1
  v_and_b32_dpp v74, v155, v7 row_ror:12 row_mask:0xf bank_mask:0x2
  v_and_b32_dpp v75, v155, v6 quad_perm:[0,1,2,3] row_mask:0xf bank_mask:0x4
  v_and_b32_dpp v75, v155, v7 row_ror:4 row_mask:0xf bank_mask:0x8
  v_and_b32_dpp v78, v155, v6 row_ror:4 row_mask:0xf bank_mask:0x1
  v_and_b32_dpp v78, v155, v7 row_ror:8 row_mask:0xf bank_mask:0x2
  v_and_b32_dpp v79, v155, v6 row_ror:12 row_mask:0xf bank_mask:0x4
  v_and_b32_dpp v79, v155, v7 quad_perm:[0,1,2,3] row_mask:0xf bank_mask:0x8
  s_nop 1
  s_waitcnt vmcnt(15)
  v_mfma_f32_16x16x32_bf16 v[156:159], v[84:87], v[18:21], 0
  v_mfma_f32_16x16x32_bf16 v[160:163], v[84:87], v[16:19], 0
  s_waitcnt vmcnt(14)
  v_mfma_f32_16x16x32_bf16 v[156:159], v[88:91], v[22:25], v[156:159]
  v_mfma_f32_16x16x32_bf16 v[160:163], v[88:91], v[20:23], v[160:163]
  s_waitcnt vmcnt(13)
  v_mfma_f32_16x16x32_bf16 v[156:159], v[92:95], v[26:29], v[156:159]
  v_mfma_f32_16x16x32_bf16 v[160:163], v[92:95], v[24:27], v[160:163]
  s_waitcnt vmcnt(12)
  v_mfma_f32_16x16x32_bf16 v[156:159], v[96:99], v[30:33], v[156:159]
  v_mfma_f32_16x16x32_bf16 v[160:163], v[96:99], v[28:31], v[160:163]
  s_waitcnt vmcnt(11)
  v_mfma_f32_16x16x32_bf16 v[156:159], v[100:103], v[34:37], v[156:159]
  v_mfma_f32_16x16x32_bf16 v[160:163], v[100:103], v[32:35], v[160:163]
  s_waitcnt vmcnt(10)
  v_mfma_f32_16x16x32_bf16 v[156:159], v[104:107], v[38:41], v[156:159]
  v_mfma_f32_16x16x32_bf16 v[160:163], v[104:107], v[36:39], v[160:163]
  s_waitcnt vmcnt(9)
  v_mfma_f32_16x16x32_bf16 v[156:159], v[108:111], v[42:45], v[156:159]
  v_mfma_f32_16x16x32_bf16 v[160:163], v[108:111], v[40:43], v[160:163]
  s_waitcnt vmcnt(8)
  v_mfma_f32_16x16x32_bf16 v[156:159], v[112:115], v[46:49], v[156:159]
  v_mfma_f32_16x16x32_bf16 v[160:163], v[112:115], v[44:47], v[160:163]
  s_waitcnt vmcnt(7)
  v_mfma_f32_16x16x32_bf16 v[156:159], v[116:119], v[50:53], v[156:159]
  v_mfma_f32_16x16x32_bf16 v[160:163], v[116:119], v[48:51], v[160:163]
  s_waitcnt vmcnt(6)
  v_mfma_f32_16x16x32_bf16 v[156:159], v[120:123], v[54:57], v[156:159]
  v_mfma_f32_16x16x32_bf16 v[160:163], v[120:123], v[52:55], v[160:163]
  s_waitcnt vmcnt(5)
  v_mfma_f32_16x16x32_bf16 v[156:159], v[124:127], v[58:61], v[156:159]
  v_mfma_f32_16x16x32_bf16 v[160:163], v[124:127], v[56:59], v[160:163]
  s_waitcnt vmcnt(4)
  v_mfma_f32_16x16x32_bf16 v[156:159], v[128:131], v[62:65], v[156:159]
  v_mfma_f32_16x16x32_bf16 v[160:163], v[128:131], v[60:63], v[160:163]
  s_waitcnt vmcnt(3)
  v_mfma_f32_16x16x32_bf16 v[156:159], v[132:135], v[66:69], v[156:159]
  v_mfma_f32_16x16x32_bf16 v[160:163], v[132:135], v[64:67], v[160:163]
  s_waitcnt vmcnt(2)
  v_mfma_f32_16x16x32_bf16 v[156:159], v[136:139], v[70:73], v[156:159]
  v_mfma_f32_16x16x32_bf16 v[160:163], v[136:139], v[68:71], v[160:163]
  s_waitcnt vmcnt(1)
  v_mfma_f32_16x16x32_bf16 v[156:159], v[140:143], v[74:77], v[156:159]
  v_mfma_f32_16x16x32_bf16 v[160:163], v[140:143], v[72:75], v[160:163]
  s_waitcnt vmcnt(0)
  v_mfma_f32_16x16x32_bf16 v[156:159], v[144:147], v[78:81], v[156:159]
  v_mfma_f32_16x16x32_bf16 v[160:163], v[144:147], v[76:79], v[160:163]
  s_lshl_b32 s33, s28, 11
  v_lshlrev_b32 v9, 5, v0
  v_add_u32 v9, s33, v9
  s_nop 6
  ds_write_b128 v9, v[156:159] offset:5632
  ds_write_b128 v9, v[160:163] offset:5648
  s_waitcnt lgkmcnt(0)
  s_barrier
  s_add_u32 m0, s35, 0
  s_nop 0
  global_load_lds_dwordx4 v8, s[12:13]
  v_add_u32 v8, 16384, v8
  s_add_u32 m0, s35, 1024
  s_nop 0
  global_load_lds_dwordx4 v8, s[12:13]
  v_add_u32 v8, 16384, v8
  s_add_u32 m0, s35, 2048
  s_nop 0
  global_load_lds_dwordx4 v8, s[12:13]
  v_add_u32 v8, 16384, v8
  s_add_u32 m0, s35, 3072
  s_nop 0
  global_load_lds_dwordx4 v8, s[12:13]
  s_cmp_lg_u32 s51, 0
  s_cbranch_scc1 L_role_20
  s_branch L_role3_22
L_role_20:
  s_cmp_eq_u32 s51, 2
  s_cbranch_scc1 L_role2_21
  s_mul_i32 s33, s28, 229376
  s_lshl_b32 s34, s50, 1
  s_add_u32 s33, s33, s34
  v_lshrrev_b32 v9, 2, v0
  v_mul_u32_u24 v9, 3584, v9
  v_lshlrev_b32 v10, 4, v3
  v_add3_u32 v9, v9, v10, s33
  s_lshl_b32 s34, s28, 12
  s_add_u32 s34, s34, 65536
  s_add_u32 m0, s34, 0
  s_nop 0
  global_load_lds_dwordx4 v9, s[16:17]
  s_add_u32 m0, s34, 32768
  s_nop 0
  global_load_lds_dwordx4 v9, s[18:19]
  s_branch L_role3_22
L_role2_21:
  s_mul_i32 s33, s28, 229376
  s_lshl_b32 s34, s50, 1
  s_add_u32 s33, s33, s34
  v_lshrrev_b32 v9, 1, v0
  v_lshlrev_b32 v9, 10, v9
  v_and_b32 v10, 1, v0
  v_lshlrev_b32 v10, 4, v10
  v_add3_u32 v9, v9, v10, s33
  s_mul_i32 s34, s28, 7168
  s_add_u32 s34, s34, 65536
  s_add_u32 m0, s34, 0
  s_nop 0
  global_load_lds_dwordx4 v9, s[20:21]
L_role3_22:
  s_lshl_b32 s36, s32, 15
  s_lshl_b32 s37, s28, 8
  s_add_u32 s36, s36, s37
  s_add_u32 s36, s36, 0x80000
  v_lshlrev_b32 v9, 11, v1
  v_and_b32 v4, 15, v0
  v_lshlrev_b32 v10, 4, v4
  v_add3_u32 v10, v9, v10, s36
  v_add_u32 v11, 8192, v10
  v_add_u32 v12, 16384, v10
  v_add_u32 v13, 24576, v10
  s_lshr_b32 s33, s28, 1
  s_lshl_b32 s33, s33, 11
  s_and_b32 s34, s28, 1
  s_lshl_b32 s34, s34, 7
  s_add_u32 s33, s33, s34
  s_add_u32 s33, s33, 32768
  v_lshlrev_b32 v5, 13, v1
  v_lshlrev_b32 v6, 9, v2
  v_lshlrev_b32 v7, 3, v3
  v_add3_u32 v5, v5, v6, v7
  v_add_u32 v5, s33, v5
  s_lshl_b32 s33, s28, 7
  v_lshlrev_b32 v6, 3, v4
  v_add_u32 v6, s33, v6
  v_lshlrev_b32 v7, 4, v1
  v_add_u32 v7, s33, v7
  s_waitcnt vmcnt(0)
  s_barrier
  ds_read_b64_tr_b16 v[96:97], v5 offset:0
  ds_read_b64_tr_b16 v[98:99], v5 offset:256
  ds_read_b64_tr_b16 v[100:101], v5 offset:32
  ds_read_b64_tr_b16 v[102:103], v5 offset:288
  ds_read_b64_tr_b16 v[104:105], v5 offset:64
  ds_read_b64_tr_b16 v[106:107], v5 offset:320
  ds_read_b64_tr_b16 v[108:109], v5 offset:96
  ds_read_b64_tr_b16 v[110:111], v5 offset:352
  s_mov_b32 s46, 4000
L_t1_23:
  global_load_dwordx4 v[16:19], v10, s[26:27] sc1
  global_load_dwordx4 v[20:23], v11, s[26:27] sc1
  global_load_dwordx4 v[24:27], v12, s[26:27] sc1
  global_load_dwordx4 v[28:31], v13, s[26:27] sc1
  s_waitcnt vmcnt(0)
  v_max_u32 v9, v16, v17
  v_max3_u32 v9, v9, v18, v19
  v_max3_u32 v9, v9, v20, v21
  v_max3_u32 v9, v9, v22, v23
  v_max3_u32 v9, v9, v24, v25
  v_max3_u32 v9, v9, v26, v27
  v_max3_u32 v9, v9, v28, v29
  v_max3_u32 v9, v9, v30, v31
  v_cmp_eq_u32 vcc, -1, v9
  s_cbranch_vccz L_t1_done_24
  s_sub_u32 s46, s46, 1
  s_cmp_lg_u32 s46, 0
  s_cbranch_scc1 L_t1_23
L_t1_done_24:
  v_add_f32 v16, v16, v20
  v_add_f32 v24, v24, v28
  v_add_f32 v17, v17, v21
  v_add_f32 v25, v25, v29
  v_add_f32 v18, v18, v22
  v_add_f32 v26, v26, v30
  v_add_f32 v19, v19, v23
  v_add_f32 v27, v27, v31
  v_add_f32 v16, v16, v24
  v_add_f32 v17, v17, v25
  v_add_f32 v18, v18, v26
  v_add_f32 v19, v19, v27
  v_mov_b32 v20, v16
  v_mov_b32 v21, v17
  v_mov_b32 v22, v18
  v_mov_b32 v23, v19
  s_nop 1
  v_permlane16_swap_b32 v16, v20
  v_permlane16_swap_b32 v17, v21
  v_permlane16_swap_b32 v18, v22
  v_permlane16_swap_b32 v19, v23
  v_add_f32 v16, v16, v20
  v_add_f32 v17, v17, v21
  v_add_f32 v18, v18, v22
  v_add_f32 v19, v19, v23
  v_mov_b32 v20, v16
  v_mov_b32 v21, v17
  v_mov_b32 v22, v18
  v_mov_b32 v23, v19
  s_nop 1
  v_permlane32_swap_b32 v16, v20
  v_permlane32_swap_b32 v17, v21
  v_permlane32_swap_b32 v18, v22
  v_permlane32_swap_b32 v19, v23
  v_add_f32 v16, v16, v20
  v_add_f32 v17, v17, v21
  v_add_f32 v18, v18, v22
  v_add_f32 v19, v19, v23
  v_cvt_pk_bf16_f32 v16, v16, v17
  v_cvt_pk_bf16_f32 v17, v18, v19
  ds_write_b64 v6, v[16:17] offset:22016
  ds_read_b128 v[88:91], v7 offset:22016
  ds_read_b128 v[92:95], v7 offset:22080
  s_waitcnt lgkmcnt(0)
  v_mfma_f32_16x16x32_bf16 v[112:115], v[88:91], v[96:99], 0
  v_mfma_f32_16x16x32_bf16 v[116:119], v[88:91], v[100:103], 0
  v_mfma_f32_16x16x32_bf16 v[112:115], v[92:95], v[104:107], v[112:115]
  v_mfma_f32_16x16x32_bf16 v[116:119], v[92:95], v[108:111], v[116:119]
  s_lshl_b32 s33, s28, 7
  v_lshlrev_b32 v9, 2, v4
  v_add_u32 v9, s33, v9
  s_nop 6
  ds_write_b32 v9, v112 offset:23040
  ds_write_b32 v9, v116 offset:23104
  s_waitcnt lgkmcnt(0)
  s_barrier
  s_cmp_eq_u32 s51, 0
  s_cbranch_scc1 L_end
  s_cmp_eq_u32 s51, 2
  s_cbranch_scc1 L_sdown
  s_mul_i32 s33, s28, 229376
  s_lshl_b32 s34, s50, 1
  s_add_u32 s33, s33, s34
  v_lshrrev_b32 v9, 2, v0
  v_mul_u32_u24 v9, 3584, v9
  v_lshlrev_b32 v10, 4, v3
  v_add3_u32 v9, v9, v10, s33
  s_lshl_b32 s34, s28, 12
  s_add_u32 s34, s34, 65536
  v_add_u32 v9, 57344, v9
  s_add_u32 m0, s34, 1024
  s_nop 0
  global_load_lds_dwordx4 v9, s[16:17]
  s_add_u32 m0, s34, 33792
  s_nop 0
  global_load_lds_dwordx4 v9, s[18:19]
  v_add_u32 v9, 57344, v9
  s_add_u32 m0, s34, 2048
  s_nop 0
  global_load_lds_dwordx4 v9, s[16:17]
  s_add_u32 m0, s34, 34816
  s_nop 0
  global_load_lds_dwordx4 v9, s[18:19]
  v_add_u32 v9, 57344, v9
  s_add_u32 m0, s34, 3072
  s_nop 0
  global_load_lds_dwordx4 v9, s[16:17]
  s_add_u32 m0, s34, 35840
  s_nop 0
  global_load_lds_dwordx4 v9, s[18:19]
  s_lshl_b32 s36, s28, 8
  s_add_u32 s36, s36, 0x100000
  v_lshrrev_b32 v5, 5, v0
  v_and_b32 v6, 1, v1
  v_lshlrev_b32 v9, 11, v5
  v_lshlrev_b32 v10, 12, v6
  v_lshlrev_b32 v11, 4, v4
  v_add3_u32 v10, v9, v10, v11
  v_add_u32 v10, s36, v10
  v_add_u32 v11, 8192, v10
  v_add_u32 v12, 16384, v10
  v_add_u32 v13, 24576, v10
  s_lshl_b32 s33, s28, 7
  v_lshlrev_b32 v6, 10, v5
  v_lshlrev_b32 v7, 3, v4
  v_add3_u32 v6, v6, v7, s33
  ds_read_b64 v[40:41], v6 offset:0
  v_lshlrev_b32 v7, 10, v5
  ds_read_u16 v42, v7 offset:0
  s_lshl_b32 s34, s28, 3
  v_lshlrev_b32 v7, 6, v5
  v_add_u32 v8, s34, v7
  v_and_b32 v9, 7, v0
  v_lshlrev_b32 v9, 3, v9
  v_add_u32 v7, v7, v9
  s_lshl_b32 s34, s28, 8
  v_lshlrev_b32 v14, 7, v5
  v_lshlrev_b32 v15, 3, v4
  v_add3_u32 v14, v14, v15, s34
  v_and_b32 v15, 1, v0
  v_lshlrev_b32 v15, 7, v15
  v_lshlrev_b32 v9, 4, v1
  v_add3_u32 v15, v15, v9, s34
  s_lshl_b32 s33, s28, 12
  s_add_u32 s33, s33, 65536
  v_lshlrev_b32 v44, 9, v1
  v_lshlrev_b32 v45, 6, v2
  v_lshlrev_b32 v46, 3, v3
  v_add3_u32 v44, v44, v45, v46
  v_add_u32 v44, s33, v44
  s_waitcnt lgkmcnt(0)
  v_lshlrev_b32 v36, 16, v40
  v_and_b32 v37, 0xffff0000, v40
  v_lshlrev_b32 v38, 16, v41
  v_and_b32 v39, 0xffff0000, v41
  v_lshlrev_b32 v42, 16, v42
  s_mov_b32 s46, 4000
L_t2_25:
  global_load_dwordx4 v[16:19], v10, s[26:27] sc1
  global_load_dwordx4 v[20:23], v11, s[26:27] sc1
  global_load_dwordx4 v[24:27], v12, s[26:27] sc1
  global_load_dwordx4 v[28:31], v13, s[26:27] sc1
  s_waitcnt vmcnt(0)
  v_max_u32 v9, v16, v17
  v_max3_u32 v9, v9, v18, v19
  v_max3_u32 v9, v9, v20, v21
  v_max3_u32 v9, v9, v22, v23
  v_max3_u32 v9, v9, v24, v25
  v_max3_u32 v9, v9, v26, v27
  v_max3_u32 v9, v9, v28, v29
  v_max3_u32 v9, v9, v30, v31
  v_cmp_eq_u32 vcc, -1, v9
  s_cbranch_vccz L_t2_done_26
  s_sub_u32 s46, s46, 1
  s_cmp_lg_u32 s46, 0
  s_cbranch_scc1 L_t2_25
L_t2_done_26:
  ds_read_b64_tr_b16 v[96:97], v44 offset:0
  ds_read_b64_tr_b16 v[98:99], v44 offset:256
  ds_read_b64_tr_b16 v[100:101], v44 offset:2048
  ds_read_b64_tr_b16 v[102:103], v44 offset:2304
  ds_read_b64_tr_b16 v[104:105], v44 offset:32
  ds_read_b64_tr_b16 v[106:107], v44 offset:288
  ds_read_b64_tr_b16 v[108:109], v44 offset:2080
  ds_read_b64_tr_b16 v[110:111], v44 offset:2336
  ds_read_b64_tr_b16 v[112:113], v44 offset:32768
  ds_read_b64_tr_b16 v[114:115], v44 offset:33024
  ds_read_b64_tr_b16 v[116:117], v44 offset:34816
  ds_read_b64_tr_b16 v[118:119], v44 offset:35072
  ds_read_b64_tr_b16 v[120:121], v44 offset:32800
  ds_read_b64_tr_b16 v[122:123], v44 offset:33056
  ds_read_b64_tr_b16 v[124:125], v44 offset:34848
  ds_read_b64_tr_b16 v[126:127], v44 offset:35104
  v_add_f32 v16, v16, v20
  v_add_f32 v24, v24, v28
  v_add_f32 v17, v17, v21
  v_add_f32 v25, v25, v29
  v_add_f32 v18, v18, v22
  v_add_f32 v26, v26, v30
  v_add_f32 v19, v19, v23
  v_add_f32 v27, v27, v31
  v_add_f32 v16, v16, v24
  v_add_f32 v17, v17, v25
  v_add_f32 v18, v18, v26
  v_add_f32 v19, v19, v27
  v_mov_b32 v20, v16
  v_mov_b32 v21, v17
  v_mov_b32 v22, v18
  v_mov_b32 v23, v19
  s_nop 1
  v_permlane16_swap_b32 v16, v20
  v_permlane16_swap_b32 v17, v21
  v_permlane16_swap_b32 v18, v22
  v_permlane16_swap_b32 v19, v23
  v_add_f32 v16, v16, v20
  v_add_f32 v17, v17, v21
  v_add_f32 v18, v18, v22
  v_add_f32 v19, v19, v23
  v_cvt_pk_bf16_f32 v20, v16, v17
  v_lshlrev_b32 v16, 16, v20
  v_and_b32 v17, 0xffff0000, v20
  v_add_f32 v16, v16, v36
  v_add_f32 v17, v17, v37
  v_cvt_pk_bf16_f32 v24, v16, v17
  v_lshlrev_b32 v16, 16, v24
  v_and_b32 v17, 0xffff0000, v24
  v_cvt_pk_bf16_f32 v20, v18, v19
  v_lshlrev_b32 v18, 16, v20
  v_and_b32 v19, 0xffff0000, v20
  v_add_f32 v18, v18, v38
  v_add_f32 v19, v19, v39
  v_cvt_pk_bf16_f32 v25, v18, v19
  v_lshlrev_b32 v18, 16, v25
  v_and_b32 v19, 0xffff0000, v25
  v_sub_f32 v20, v16, v42
  v_sub_f32 v21, v17, v42
  v_sub_f32 v22, v18, v42
  v_sub_f32 v23, v19, v42
  v_add_f32 v26, v20, v21
  v_mul_f32 v27, v20, v20
  v_add_f32 v26, v26, v22
  v_fmac_f32 v27, v21, v21
  v_add_f32 v26, v26, v23
  v_fmac_f32 v27, v22, v22
  v_fmac_f32 v27, v23, v23
  s_nop 1
  v_add_f32_dpp v26, v26, v26 quad_perm:[1,0,3,2] row_mask:0xf bank_mask:0xf
  v_add_f32_dpp v27, v27, v27 quad_perm:[1,0,3,2] row_mask:0xf bank_mask:0xf
  s_nop 1
  v_add_f32_dpp v26, v26, v26 quad_perm:[2,3,0,1] row_mask:0xf bank_mask:0xf
  v_add_f32_dpp v27, v27, v27 quad_perm:[2,3,0,1] row_mask:0xf bank_mask:0xf
  s_nop 1
  v_add_f32_dpp v26, v26, v26 row_ror:4 row_mask:0xf bank_mask:0xf
  v_add_f32_dpp v27, v27, v27 row_ror:4 row_mask:0xf bank_mask:0xf
  s_nop 1
  v_add_f32_dpp v26, v26, v26 row_ror:8 row_mask:0xf bank_mask:0xf
  v_add_f32_dpp v27, v27, v27 row_ror:8 row_mask:0xf bank_mask:0xf
  ds_write_b64 v8, v[26:27] offset:24064
  s_waitcnt lgkmcnt(0)
  s_barrier
  ds_read_b64 v[26:27], v7 offset:24064
  s_waitcnt lgkmcnt(0)
  s_nop 1
  v_add_f32_dpp v26, v26, v26 quad_perm:[1,0,3,2] row_mask:0xf bank_mask:0xf
  v_add_f32_dpp v27, v27, v27 quad_perm:[1,0,3,2] row_mask:0xf bank_mask:0xf
  s_nop 1
  v_add_f32_dpp v26, v26, v26 quad_perm:[2,3,0,1] row_mask:0xf bank_mask:0xf
  v_add_f32_dpp v27, v27, v27 quad_perm:[2,3,0,1] row_mask:0xf bank_mask:0xf
  s_nop 1
  v_add_f32_dpp v26, v26, v26 row_ror:4 row_mask:0xf bank_mask:0xf
  v_add_f32_dpp v27, v27, v27 row_ror:4 row_mask:0xf bank_mask:0xf
  v_mul_f32 v26, 0x3b000000, v26
  v_mul_f32 v27, 0x3b000000, v27
  v_fma_f32 v27, -v26, v26, v27
  v_max_f32 v27, 0, v27
  v_add_f32 v26, v26, v42
  v_cvt_pk_bf16_f32 v29, v27, v27
  v_lshlrev_b32 v27, 16, v29
  v_add_f32 v27, 0x3727c5ac, v27
  v_cvt_pk_bf16_f32 v29, v27, v27
  v_lshlrev_b32 v27, 16, v29
  v_sqrt_f32 v27, v27
  v_cvt_pk_bf16_f32 v29, v26, v26
  v_lshlrev_b32 v26, 16, v29
  v_cvt_pk_bf16_f32 v29, v27, v27
  v_lshlrev_b32 v27, 16, v29
  v_rcp_f32 v28, v27
  s_nop 0
  v_sub_f32 v30, v16, v26
  v_sub_f32 v31, v17, v26
  v_cvt_pk_bf16_f32 v32, v30, v31
  v_lshlrev_b32 v30, 16, v32
  v_and_b32 v31, 0xffff0000, v32
  v_mul_f32 v32, v30, v28
  v_mul_f32 v33, v31, v28
  v_fma_f32 v34, -v32, v27, v30
  v_fma_f32 v35, -v33, v27, v31
  v_fmac_f32 v32, v34, v28
  v_fmac_f32 v33, v35, v28
  v_cvt_pk_bf16_f32 v24, v32, v33
  v_sub_f32 v30, v18, v26
  v_sub_f32 v31, v19, v26
  v_cvt_pk_bf16_f32 v32, v30, v31
  v_lshlrev_b32 v30, 16, v32
  v_and_b32 v31, 0xffff0000, v32
  v_mul_f32 v32, v30, v28
  v_mul_f32 v33, v31, v28
  v_fma_f32 v34, -v32, v27, v30
  v_fma_f32 v35, -v33, v27, v31
  v_fmac_f32 v32, v34, v28
  v_fmac_f32 v33, v35, v28
  v_cvt_pk_bf16_f32 v25, v32, v33
  ds_write_b64 v14, v[24:25] offset:24320
  ds_read_b128 v[88:91], v15 offset:24320
  ds_read_b128 v[92:95], v15 offset:24384
  s_waitcnt lgkmcnt(0)
  v_mfma_f32_16x16x32_bf16 v[128:131], v[88:91], v[96:99], 0
  v_mfma_f32_16x16x32_bf16 v[132:135], v[88:91], v[104:107], 0
  v_mfma_f32_16x16x32_bf16 v[136:139], v[88:91], v[112:115], 0
  v_mfma_f32_16x16x32_bf16 v[140:143], v[88:91], v[120:123], 0
  v_mfma_f32_16x16x32_bf16 v[128:131], v[92:95], v[100:103], v[128:131]
  v_mfma_f32_16x16x32_bf16 v[132:135], v[92:95], v[108:111], v[132:135]
  v_mfma_f32_16x16x32_bf16 v[136:139], v[92:95], v[116:119], v[136:139]
  v_mfma_f32_16x16x32_bf16 v[140:143], v[92:95], v[124:127], v[140:143]
  s_lshl_b32 s33, s28, 9
  v_lshlrev_b32 v9, 2, v4
  v_add_u32 v9, s33, v9
  s_nop 4
  ds_write_b32 v9, v128 offset:26368
  ds_write_b32 v9, v129 offset:26624
  ds_write_b32 v9, v132 offset:26432
  ds_write_b32 v9, v133 offset:26688
  ds_write_b32 v9, v136 offset:26496
  ds_write_b32 v9, v137 offset:26752
  ds_write_b32 v9, v140 offset:26560
  ds_write_b32 v9, v141 offset:26816
  s_waitcnt lgkmcnt(0)
  s_barrier
  s_branch L_end
L_sdown:
  s_mul_i32 s33, s28, 229376
  s_lshl_b32 s34, s50, 1
  s_add_u32 s33, s33, s34
  v_lshrrev_b32 v9, 1, v0
  v_lshlrev_b32 v9, 10, v9
  v_and_b32 v10, 1, v0
  v_lshlrev_b32 v10, 4, v10
  v_add3_u32 v9, v9, v10, s33
  s_mul_i32 s34, s28, 7168
  s_add_u32 s34, s34, 65536
  v_add_u32 v9, 32768, v9
  s_add_u32 m0, s34, 1024
  s_nop 0
  global_load_lds_dwordx4 v9, s[20:21]
  v_add_u32 v9, 32768, v9
  s_add_u32 m0, s34, 2048
  s_nop 0
  global_load_lds_dwordx4 v9, s[20:21]
  v_add_u32 v9, 32768, v9
  s_add_u32 m0, s34, 3072
  s_nop 0
  global_load_lds_dwordx4 v9, s[20:21]
  v_add_u32 v9, 32768, v9
  s_add_u32 m0, s34, 4096
  s_nop 0
  global_load_lds_dwordx4 v9, s[20:21]
  v_add_u32 v9, 32768, v9
  s_add_u32 m0, s34, 5120
  s_nop 0
  global_load_lds_dwordx4 v9, s[20:21]
  v_add_u32 v9, 32768, v9
  s_add_u32 m0, s34, 6144
  s_nop 0
  global_load_lds_dwordx4 v9, s[20:21]
  s_mul_i32 s33, s28, 448
  s_add_u32 s33, s33, 0x110000
  v_min_u32 v5, 55, v0
  v_cmp_lt_u32 vcc, 27, v5
  v_mov_b32 v6, 0
  v_mov_b32 v7, 3136
  v_cndmask_b32 v6, v6, v7, vcc
  v_lshlrev_b32 v5, 4, v5
  v_add3_u32 v9, v5, v6, s33
  s_lshl_b32 s34, s28, 10
  v_add_u32 v5, s34, v5
  v_and_b32 v6, 1, v0
  v_mul_u32_u24 v6, 448, v6
  v_lshlrev_b32 v7, 4, v1
  v_add3_u32 v6, v6, v7, s34
  s_mul_i32 s33, s28, 7168
  s_add_u32 s33, s33, 65536
  v_lshlrev_b32 v11, 8, v1
  v_lshlrev_b32 v12, 5, v2
  v_lshlrev_b32 v13, 3, v3
  v_add3_u32 v11, v11, v12, v13
  v_add_u32 v11, s33, v11
  s_lshl_b32 s33, s28, 7
  v_lshlrev_b32 v10, 2, v4
  v_add_u32 v10, s33, v10
  s_waitcnt vmcnt(0)
  ds_read_b64_tr_b16 v[48:49], v11 offset:0
  ds_read_b64_tr_b16 v[50:51], v11 offset:128
  ds_read_b64_tr_b16 v[52:53], v11 offset:1024
  ds_read_b64_tr_b16 v[54:55], v11 offset:1152
  ds_read_b64_tr_b16 v[56:57], v11 offset:2048
  ds_read_b64_tr_b16 v[58:59], v11 offset:2176
  ds_read_b64_tr_b16 v[60:61], v11 offset:3072
  ds_read_b64_tr_b16 v[62:63], v11 offset:3200
  ds_read_b64_tr_b16 v[64:65], v11 offset:4096
  ds_read_b64_tr_b16 v[66:67], v11 offset:4224
  ds_read_b64_tr_b16 v[68:69], v11 offset:5120
  ds_read_b64_tr_b16 v[70:71], v11 offset:5248
  ds_read_b64_tr_b16 v[72:73], v11 offset:6144
  ds_read_b64_tr_b16 v[74:75], v11 offset:6272
  s_mov_b32 s46, 4000
L_t3_27:
  global_load_dwordx4 v[84:87], v9, s[26:27] sc1
  s_waitcnt vmcnt(0)
  v_max_u32 v12, v84, v85
  v_max3_u32 v12, v12, v86, v87
  v_cmp_eq_u32 vcc, -1, v12
  s_cbranch_vccz L_t3_done_28
  s_sub_u32 s46, s46, 1
  s_cmp_lg_u32 s46, 0
  s_cbranch_scc1 L_t3_27
L_t3_done_28:
  ds_write_b128 v5, v[84:87] offset:5632
  ds_read_b128 v[16:19], v6 offset:5632
  ds_read_b128 v[20:23], v6 offset:5696
  ds_read_b128 v[24:27], v6 offset:5760
  ds_read_b128 v[28:31], v6 offset:5824
  ds_read_b128 v[32:35], v6 offset:5888
  ds_read_b128 v[36:39], v6 offset:5952
  ds_read_b128 v[40:43], v6 offset:6016
  s_waitcnt lgkmcnt(0)
  v_mfma_f32_16x16x32_bf16 v[112:115], v[16:19], v[48:51], 0
  v_mfma_f32_16x16x32_bf16 v[112:115], v[20:23], v[52:55], v[112:115]
  v_mfma_f32_16x16x32_bf16 v[112:115], v[24:27], v[56:59], v[112:115]
  v_mfma_f32_16x16x32_bf16 v[112:115], v[28:31], v[60:63], v[112:115]
  v_mfma_f32_16x16x32_bf16 v[112:115], v[32:35], v[64:67], v[112:115]
  v_mfma_f32_16x16x32_bf16 v[112:115], v[36:39], v[68:71], v[112:115]
  v_mfma_f32_16x16x32_bf16 v[112:115], v[40:43], v[72:75], v[112:115]
  s_nop 7
  ds_write_b32 v10, v112 offset:26368
  ds_write_b32 v10, v113 offset:26432
  s_waitcnt lgkmcnt(0)
  s_barrier
  s_branch L_end
L_qk:
  v_lshlrev_b32 v9, 8, v3
  v_lshlrev_b32 v10, 6, v1
  v_lshlrev_b32 v11, 4, v2
  v_add3_u32 v9, v9, v10, v11
  ds_read_b128 v[148:151], v9 offset:4096
  s_waitcnt lgkmcnt(0)
  v_mfma_f32_16x16x32_bf16 v[16:19], v[20:23], v[148:151], 0
  v_mfma_f32_16x16x32_bf16 v[20:23], v[24:27], v[148:151], 0
  v_mfma_f32_16x16x32_bf16 v[24:27], v[28:31], v[148:151], 0
  v_mfma_f32_16x16x32_bf16 v[28:31], v[32:35], v[148:151], 0
  v_mfma_f32_16x16x32_bf16 v[32:35], v[36:39], v[148:151], 0
  v_mfma_f32_16x16x32_bf16 v[36:39], v[40:43], v[148:151], 0
  v_mfma_f32_16x16x32_bf16 v[40:43], v[44:47], v[148:151], 0
  v_mfma_f32_16x16x32_bf16 v[44:47], v[48:51], v[148:151], 0
  v_mfma_f32_16x16x32_bf16 v[48:51], v[52:55], v[148:151], 0
  v_mfma_f32_16x16x32_bf16 v[52:55], v[56:59], v[148:151], 0
  v_mfma_f32_16x16x32_bf16 v[56:59], v[60:63], v[148:151], 0
  v_mfma_f32_16x16x32_bf16 v[60:63], v[64:67], v[148:151], 0
  v_mfma_f32_16x16x32_bf16 v[64:67], v[68:71], v[148:151], 0
  v_mfma_f32_16x16x32_bf16 v[68:71], v[72:75], v[148:151], 0
  v_mfma_f32_16x16x32_bf16 v[72:75], v[76:79], v[148:151], 0
  v_mfma_f32_16x16x32_bf16 v[76:79], v[80:83], v[148:151], 0
  s_nop 3
  v_add_f32_dpp v16, v17, v16 row_ror:12 row_mask:0xf bank_mask:0xf
  v_add_f32_dpp v21, v22, v21 row_ror:12 row_mask:0xf bank_mask:0xf
  v_add_f32_dpp v26, v27, v26 row_ror:12 row_mask:0xf bank_mask:0xf
  v_add_f32_dpp v31, v28, v31 row_ror:12 row_mask:0xf bank_mask:0xf
  v_add_f32_dpp v32, v33, v32 row_ror:12 row_mask:0xf bank_mask:0xf
  v_add_f32_dpp v37, v38, v37 row_ror:12 row_mask:0xf bank_mask:0xf
  v_add_f32_dpp v42, v43, v42 row_ror:12 row_mask:0xf bank_mask:0xf
  v_add_f32_dpp v47, v44, v47 row_ror:12 row_mask:0xf bank_mask:0xf
  v_add_f32_dpp v48, v49, v48 row_ror:12 row_mask:0xf bank_mask:0xf
  v_add_f32_dpp v53, v54, v53 row_ror:12 row_mask:0xf bank_mask:0xf
  v_add_f32_dpp v58, v59, v58 row_ror:12 row_mask:0xf bank_mask:0xf
  v_add_f32_dpp v63, v60, v63 row_ror:12 row_mask:0xf bank_mask:0xf
  v_add_f32_dpp v64, v65, v64 row_ror:12 row_mask:0xf bank_mask:0xf
  v_add_f32_dpp v69, v70, v69 row_ror:12 row_mask:0xf bank_mask:0xf
  v_add_f32_dpp v74, v75, v74 row_ror:12 row_mask:0xf bank_mask:0xf
  v_add_f32_dpp v79, v76, v79 row_ror:12 row_mask:0xf bank_mask:0xf
  v_add_f32_dpp v16, v18, v16 row_ror:8 row_mask:0xf bank_mask:0xf
  v_add_f32_dpp v21, v23, v21 row_ror:8 row_mask:0xf bank_mask:0xf
  v_add_f32_dpp v26, v24, v26 row_ror:8 row_mask:0xf bank_mask:0xf
  v_add_f32_dpp v31, v29, v31 row_ror:8 row_mask:0xf bank_mask:0xf
  v_add_f32_dpp v32, v34, v32 row_ror:8 row_mask:0xf bank_mask:0xf
  v_add_f32_dpp v37, v39, v37 row_ror:8 row_mask:0xf bank_mask:0xf
  v_add_f32_dpp v42, v40, v42 row_ror:8 row_mask:0xf bank_mask:0xf
  v_add_f32_dpp v47, v45, v47 row_ror:8 row_mask:0xf bank_mask:0xf
  v_add_f32_dpp v48, v50, v48 row_ror:8 row_mask:0xf bank_mask:0xf
  v_add_f32_dpp v53, v55, v53 row_ror:8 row_mask:0xf bank_mask:0xf
  v_add_f32_dpp v58, v56, v58 row_ror:8 row_mask:0xf bank_mask:0xf
  v_add_f32_dpp v63, v61, v63 row_ror:8 row_mask:0xf bank_mask:0xf
  v_add_f32_dpp v64, v66, v64 row_ror:8 row_mask:0xf bank_mask:0xf
  v_add_f32_dpp v69, v71, v69 row_ror:8 row_mask:0xf bank_mask:0xf
  v_add_f32_dpp v74, v72, v74 row_ror:8 row_mask:0xf bank_mask:0xf
  v_add_f32_dpp v79, v77, v79 row_ror:8 row_mask:0xf bank_mask:0xf
  v_add_f32_dpp v152, v19, v16 row_ror:4 row_mask:0xf bank_mask:0x1
  v_add_f32_dpp v152, v20, v21 row_ror:4 row_mask:0xf bank_mask:0x2
  v_add_f32_dpp v152, v25, v26 row_ror:4 row_mask:0xf bank_mask:0x4
  v_add_f32_dpp v152, v30, v31 row_ror:4 row_mask:0xf bank_mask:0x8
  v_add_f32_dpp v153, v35, v32 row_ror:4 row_mask:0xf bank_mask:0x1
  v_add_f32_dpp v153, v36, v37 row_ror:4 row_mask:0xf bank_mask:0x2
  v_add_f32_dpp v153, v41, v42 row_ror:4 row_mask:0xf bank_mask:0x4
  v_add_f32_dpp v153, v46, v47 row_ror:4 row_mask:0xf bank_mask:0x8
  v_add_f32_dpp v154, v51, v48 row_ror:4 row_mask:0xf bank_mask:0x1
  v_add_f32_dpp v154, v52, v53 row_ror:4 row_mask:0xf bank_mask:0x2
  v_add_f32_dpp v154, v57, v58 row_ror:4 row_mask:0xf bank_mask:0x4
  v_add_f32_dpp v154, v62, v63 row_ror:4 row_mask:0xf bank_mask:0x8
  v_add_f32_dpp v155, v67, v64 row_ror:4 row_mask:0xf bank_mask:0x1
  v_add_f32_dpp v155, v68, v69 row_ror:4 row_mask:0xf bank_mask:0x2
  v_add_f32_dpp v155, v73, v74 row_ror:4 row_mask:0xf bank_mask:0x4
  v_add_f32_dpp v155, v78, v79 row_ror:4 row_mask:0xf bank_mask:0x8
  v_cvt_pk_bf16_f32 v9, v152, v153
  v_lshlrev_b32 v10, 16, v9
  v_and_b32 v11, 0xffff0000, v9
  v_mul_f32 v10, s45, v10
  v_mul_f32 v11, s45, v11
  v_cvt_pk_bf16_f32 v9, v10, v11
  v_lshlrev_b32 v152, 16, v9
  v_and_b32 v153, 0xffff0000, v9
  v_cvt_pk_bf16_f32 v9, v154, v155
  v_lshlrev_b32 v10, 16, v9
  v_and_b32 v11, 0xffff0000, v9
  v_mul_f32 v10, s45, v10
  v_mul_f32 v11, s45, v11
  v_cvt_pk_bf16_f32 v9, v10, v11
  v_lshlrev_b32 v154, 16, v9
  v_and_b32 v155, 0xffff0000, v9
  v_max3_f32 v12, v152, v153, v154
  v_max_f32 v12, v12, v155
  s_nop 1
  v_max_f32_dpp v12, v12, v12 row_ror:4 row_mask:0xf bank_mask:0xf
  s_nop 1
  v_max_f32_dpp v12, v12, v12 row_ror:8 row_mask:0xf bank_mask:0xf
  v_mov_b32 v9, v12
  s_nop 1
  v_permlane16_swap_b32 v12, v9
  v_max_f32 v12, v12, v9
  v_mov_b32 v9, v12
  s_nop 1
  v_permlane32_swap_b32 v12, v9
  v_max_f32 v12, v12, v9
  v_sub_f32 v16, v152, v12
  v_mul_f32 v16, s44, v16
  v_exp_f32 v16, v16
  v_sub_f32 v17, v153, v12
  v_mul_f32 v17, s44, v17
  v_exp_f32 v17, v17
  v_sub_f32 v18, v154, v12
  v_mul_f32 v18, s44, v18
  v_exp_f32 v18, v18
  v_sub_f32 v19, v155, v12
  v_mul_f32 v19, s44, v19
  v_exp_f32 v19, v19
  s_nop 0
  v_add_f32 v13, v16, v17
  v_add_f32 v13, v13, v18
  v_add_f32 v13, v13, v19
  s_nop 1
  v_add_f32_dpp v13, v13, v13 row_ror:4 row_mask:0xf bank_mask:0xf
  s_nop 1
  v_add_f32_dpp v13, v13, v13 row_ror:8 row_mask:0xf bank_mask:0xf
  v_mov_b32 v9, v13
  s_nop 1
  v_permlane16_swap_b32 v13, v9
  v_add_f32 v13, v13, v9
  v_mov_b32 v9, v13
  s_nop 1
  v_permlane32_swap_b32 v13, v9
  v_add_f32 v13, v13, v9
  s_lshl_b32 s33, s28, 5
  v_lshlrev_b32 v9, 3, v3
  v_add_u32 v9, s33, v9
  ds_write_b64 v9, v[12:13] offset:5120
  v_mov_b32 v10, 1
  s_waitcnt lgkmcnt(0)
  ds_add_u32 v164, v10 offset:5508
  s_mov_b32 s49, 2
  s_setpc_b64 s[54:55]
L_ctrl:
  s_setprio 3
  s_cmp_lg_u32 s2, 255
  s_cbranch_scc1 L_nonce_29
  s_memrealtime s[52:53]
  s_waitcnt lgkmcnt(0)
  s_or_b32 s52, s52, 1
  v_mov_b32 v12, s52
  v_mov_b32 v13, 0
  v_mov_b32 v14, 0
  s_mov_b64 exec, 0x1
  global_atomic_cmpswap v14, v[12:13], s[24:25] sc1
  s_mov_b64 exec, -1
L_nonce_29:
  v_lshlrev_b32 v1, 4, v0
  v_mov_b32 v164, 0
  v_mov_b32 v165, 0
  v_mov_b32 v166, 0
  v_mov_b32 v167, 0
  ds_write_b128 v164, v[164:167] offset:5504
  s_waitcnt lgkmcnt(0)
  s_bfe_u32 s33, s2, 0x20003
  s_lshl_b32 s34, s58, 2
  s_add_u32 s36, s33, s34
  s_bfe_u32 s37, s2, 0x20005
  v_lshrrev_b32 v2, 4, v0
  v_and_b32 v3, 15, v0
  s_lshl_b32 s34, s29, 12
  s_lshl_b32 s35, s30, 11
  s_add_u32 s34, s34, s35
  s_lshl_b32 s35, s59, 7
  s_add_u32 s34, s34, s35
  s_add_u32 s38, s34, 0x100000
  s_cmp_ge_u32 s2, 128
  s_cbranch_scc1 L_noprod_30
  global_load_dwordx4 v[4:7], v1, s[4:5]
  global_load_dwordx4 v[8:11], v1, s[4:5] offset:1024
  s_lshl_b32 s33, s37, 20
  s_lshl_b32 s34, s36, 8
  s_add_u32 s33, s33, s34
  v_lshlrev_b32 v12, 13, v2
  v_lshlrev_b32 v13, 4, v3
  v_add3_u32 v12, v12, v13, s33
  global_load_dwordx4 v[16:19], v12, s[10:11] nt
  v_add_u32 v12, 0x8000, v12
  global_load_dwordx4 v[20:23], v12, s[10:11] nt
  v_add_u32 v12, 0x8000, v12
  global_load_dwordx4 v[24:27], v12, s[10:11] nt
  v_add_u32 v12, 0x8000, v12
  global_load_dwordx4 v[28:31], v12, s[10:11] nt
  v_add_u32 v12, 0x8000, v12
  global_load_dwordx4 v[32:35], v12, s[10:11] nt
  v_add_u32 v12, 0x8000, v12
  global_load_dwordx4 v[36:39], v12, s[10:11] nt
  v_add_u32 v12, 0x8000, v12
  global_load_dwordx4 v[40:43], v12, s[10:11] nt
  v_add_u32 v12, 0x8000, v12
  global_load_dwordx4 v[44:47], v12, s[10:11] nt
  v_add_u32 v12, 0x8000, v12
  global_load_dwordx4 v[48:51], v12, s[10:11] nt
  v_add_u32 v12, 0x8000, v12
  global_load_dwordx4 v[52:55], v12, s[10:11] nt
  v_add_u32 v12, 0x8000, v12
  global_load_dwordx4 v[56:59], v12, s[10:11] nt
  v_add_u32 v12, 0x8000, v12
  global_load_dwordx4 v[60:63], v12, s[10:11] nt
  v_add_u32 v12, 0x8000, v12
  global_load_dwordx4 v[64:67], v12, s[10:11] nt
  v_add_u32 v12, 0x8000, v12
  global_load_dwordx4 v[68:71], v12, s[10:11] nt
  v_add_u32 v12, 0x8000, v12
  global_load_dwordx4 v[72:75], v12, s[10:11] nt
  v_add_u32 v12, 0x8000, v12
  global_load_dwordx4 v[76:79], v12, s[10:11] nt
  v_add_u32 v12, 0x8000, v12
  global_load_dwordx4 v[80:83], v12, s[10:11] nt
  v_add_u32 v12, 0x8000, v12
  global_load_dwordx4 v[84:87], v12, s[10:11] nt
  v_add_u32 v12, 0x8000, v12
  global_load_dwordx4 v[88:91], v12, s[10:11] nt
  v_add_u32 v12, 0x8000, v12
  global_load_dwordx4 v[92:95], v12, s[10:11] nt
  v_add_u32 v12, 0x8000, v12
  global_load_dwordx4 v[96:99], v12, s[10:11] nt
  v_add_u32 v12, 0x8000, v12
  global_load_dwordx4 v[100:103], v12, s[10:11] nt
  v_add_u32 v12, 0x8000, v12
  global_load_dwordx4 v[104:107], v12, s[10:11] nt
  v_add_u32 v12, 0x8000, v12
  global_load_dwordx4 v[108:111], v12, s[10:11] nt
  v_add_u32 v12, 0x8000, v12
  global_load_dwordx4 v[112:115], v12, s[10:11] nt
  v_add_u32 v12, 0x8000, v12
  global_load_dwordx4 v[116:119], v12, s[10:11] nt
  v_add_u32 v12, 0x8000, v12
  global_load_dwordx4 v[120:123], v12, s[10:11] nt
  v_add_u32 v12, 0x8000, v12
  global_load_dwordx4 v[124:127], v12, s[10:11] nt
  v_add_u32 v12, 0x8000, v12
  global_load_dwordx4 v[128:131], v12, s[10:11] nt
  v_add_u32 v12, 0x8000, v12
  global_load_dwordx4 v[132:135], v12, s[10:11] nt
  v_add_u32 v12, 0x8000, v12
  global_load_dwordx4 v[136:139], v12, s[10:11] nt
  v_add_u32 v12, 0x8000, v12
  global_load_dwordx4 v[140:143], v12, s[10:11] nt
  s_barrier
  s_waitcnt vmcnt(32)
  ds_write_b128 v1, v[4:7] offset:0
  ds_write_b128 v1, v[8:11] offset:1024
  v_lshlrev_b32 v144, 16, v4
  v_and_b32 v145, 0xffff0000, v4
  v_lshlrev_b32 v146, 16, v5
  v_and_b32 v147, 0xffff0000, v5
  v_lshlrev_b32 v148, 16, v6
  v_and_b32 v149, 0xffff0000, v6
  v_lshlrev_b32 v150, 16, v7
  v_and_b32 v151, 0xffff0000, v7
  v_lshlrev_b32 v152, 16, v8
  v_and_b32 v153, 0xffff0000, v8
  v_lshlrev_b32 v154, 16, v9
  v_and_b32 v155, 0xffff0000, v9
  v_lshlrev_b32 v156, 16, v10
  v_and_b32 v157, 0xffff0000, v10
  v_lshlrev_b32 v158, 16, v11
  v_and_b32 v159, 0xffff0000, v11
  v_add_f32 v12, v144, v145
  v_add_f32 v12, v12, v146
  v_add_f32 v12, v12, v147
  v_add_f32 v12, v12, v148
  v_add_f32 v12, v12, v149
  v_add_f32 v12, v12, v150
  v_add_f32 v12, v12, v151
  v_add_f32 v13, v152, v153
  v_add_f32 v13, v13, v154
  v_add_f32 v13, v13, v155
  v_add_f32 v13, v13, v156
  v_add_f32 v13, v13, v157
  v_add_f32 v13, v13, v158
  v_add_f32 v13, v13, v159
  s_nop 1
  v_add_f32_dpp v12, v12, v12 quad_perm:[1,0,3,2] row_mask:0xf bank_mask:0xf
  v_add_f32_dpp v13, v13, v13 quad_perm:[1,0,3,2] row_mask:0xf bank_mask:0xf
  s_nop 1
  v_add_f32_dpp v12, v12, v12 quad_perm:[2,3,0,1] row_mask:0xf bank_mask:0xf
  v_add_f32_dpp v13, v13, v13 quad_perm:[2,3,0,1] row_mask:0xf bank_mask:0xf
  s_nop 1
  v_add_f32_dpp v12, v12, v12 row_ror:4 row_mask:0xf bank_mask:0xf
  v_add_f32_dpp v13, v13, v13 row_ror:4 row_mask:0xf bank_mask:0xf
  s_nop 1
  v_add_f32_dpp v12, v12, v12 row_ror:8 row_mask:0xf bank_mask:0xf
  v_add_f32_dpp v13, v13, v13 row_ror:8 row_mask:0xf bank_mask:0xf
  v_mov_b32 v162, v12
  v_mov_b32 v163, v13
  s_nop 1
  v_permlane16_swap_b32 v12, v162
  v_permlane16_swap_b32 v13, v163
  v_add_f32 v12, v12, v162
  v_add_f32 v13, v13, v163
  v_mov_b32 v162, v12
  v_mov_b32 v163, v13
  s_nop 1
  v_permlane32_swap_b32 v12, v162
  v_permlane32_swap_b32 v13, v163
  v_add_f32 v12, v12, v162
  v_add_f32 v13, v13, v163
  v_mul_f32 v12, 0x3b000000, v12
  v_mul_f32 v13, 0x3b000000, v13
  v_sub_f32 v162, v144, v12
  v_mul_f32 v14, v162, v162
  v_sub_f32 v163, v145, v12
  v_fmac_f32 v14, v163, v163
  v_sub_f32 v164, v146, v12
  v_fmac_f32 v14, v164, v164
  v_sub_f32 v165, v147, v12
  v_fmac_f32 v14, v165, v165
  v_sub_f32 v162, v148, v12
  v_fmac_f32 v14, v162, v162
  v_sub_f32 v163, v149, v12
  v_fmac_f32 v14, v163, v163
  v_sub_f32 v164, v150, v12
  v_fmac_f32 v14, v164, v164
  v_sub_f32 v165, v151, v12
  v_fmac_f32 v14, v165, v165
  v_sub_f32 v162, v152, v13
  v_mul_f32 v15, v162, v162
  v_sub_f32 v163, v153, v13
  v_fmac_f32 v15, v163, v163
  v_sub_f32 v164, v154, v13
  v_fmac_f32 v15, v164, v164
  v_sub_f32 v165, v155, v13
  v_fmac_f32 v15, v165, v165
  v_sub_f32 v162, v156, v13
  v_fmac_f32 v15, v162, v162
  v_sub_f32 v163, v157, v13
  v_fmac_f32 v15, v163, v163
  v_sub_f32 v164, v158, v13
  v_fmac_f32 v15, v164, v164
  v_sub_f32 v165, v159, v13
  v_fmac_f32 v15, v165, v165
  s_nop 1
  v_add_f32_dpp v14, v14, v14 quad_perm:[1,0,3,2] row_mask:0xf bank_mask:0xf
  v_add_f32_dpp v15, v15, v15 quad_perm:[1,0,3,2] row_mask:0xf bank_mask:0xf
  s_nop 1
  v_add_f32_dpp v14, v14, v14 quad_perm:[2,3,0,1] row_mask:0xf bank_mask:0xf
  v_add_f32_dpp v15, v15, v15 quad_perm:[2,3,0,1] row_mask:0xf bank_mask:0xf
  s_nop 1
  v_add_f32_dpp v14, v14, v14 row_ror:4 row_mask:0xf bank_mask:0xf
  v_add_f32_dpp v15, v15, v15 row_ror:4 row_mask:0xf bank_mask:0xf
  s_nop 1
  v_add_f32_dpp v14, v14, v14 row_ror:8 row_mask:0xf bank_mask:0xf
  v_add_f32_dpp v15, v15, v15 row_ror:8 row_mask:0xf bank_mask:0xf
  v_mov_b32 v162, v14
  v_mov_b32 v163, v15
  s_nop 1
  v_permlane16_swap_b32 v14, v162
  v_permlane16_swap_b32 v15, v163
  v_add_f32 v14, v14, v162
  v_add_f32 v15, v15, v163
  v_mov_b32 v162, v14
  v_mov_b32 v163, v15
  s_nop 1
  v_permlane32_swap_b32 v14, v162
  v_permlane32_swap_b32 v15, v163
  v_add_f32 v14, v14, v162
  v_add_f32 v15, v15, v163
  v_mul_f32 v14, 0x3b000000, v14
  v_cvt_pk_bf16_f32 v162, v14, v14
  v_lshlrev_b32 v14, 16, v162
  v_add_f32 v14, 0x3727c5ac, v14
  v_cvt_pk_bf16_f32 v162, v14, v14
  v_lshlrev_b32 v14, 16, v162
  v_sqrt_f32 v14, v14
  v_cvt_pk_bf16_f32 v162, v12, v12
  v_lshlrev_b32 v12, 16, v162
  v_cvt_pk_bf16_f32 v162, v14, v14
  v_lshlrev_b32 v14, 16, v162
  v_rcp_f32 v160, v14
  s_nop 0
  v_mul_f32 v15, 0x3b000000, v15
  v_cvt_pk_bf16_f32 v162, v15, v15
  v_lshlrev_b32 v15, 16, v162
  v_add_f32 v15, 0x3727c5ac, v15
  v_cvt_pk_bf16_f32 v162, v15, v15
  v_lshlrev_b32 v15, 16, v162
  v_sqrt_f32 v15, v15
  v_cvt_pk_bf16_f32 v162, v13, v13
  v_lshlrev_b32 v13, 16, v162
  v_cvt_pk_bf16_f32 v162, v15, v15
  v_lshlrev_b32 v15, 16, v162
  v_rcp_f32 v161, v15
  s_nop 0
  v_sub_f32 v162, v144, v12
  v_sub_f32 v163, v145, v12
  v_cvt_pk_bf16_f32 v164, v162, v163
  v_lshlrev_b32 v162, 16, v164
  v_and_b32 v163, 0xffff0000, v164
  v_mul_f32 v164, v162, v160
  v_mul_f32 v165, v163, v160
  v_fma_f32 v166, -v164, v14, v162
  v_fma_f32 v167, -v165, v14, v163
  v_fmac_f32 v164, v166, v160
  v_fmac_f32 v165, v167, v160
  v_cvt_pk_bf16_f32 v4, v164, v165
  v_sub_f32 v162, v146, v12
  v_sub_f32 v163, v147, v12
  v_cvt_pk_bf16_f32 v164, v162, v163
  v_lshlrev_b32 v162, 16, v164
  v_and_b32 v163, 0xffff0000, v164
  v_mul_f32 v164, v162, v160
  v_mul_f32 v165, v163, v160
  v_fma_f32 v166, -v164, v14, v162
  v_fma_f32 v167, -v165, v14, v163
  v_fmac_f32 v164, v166, v160
  v_fmac_f32 v165, v167, v160
  v_cvt_pk_bf16_f32 v5, v164, v165
  v_sub_f32 v162, v148, v12
  v_sub_f32 v163, v149, v12
  v_cvt_pk_bf16_f32 v164, v162, v163
  v_lshlrev_b32 v162, 16, v164
  v_and_b32 v163, 0xffff0000, v164
  v_mul_f32 v164, v162, v160
  v_mul_f32 v165, v163, v160
  v_fma_f32 v166, -v164, v14, v162
  v_fma_f32 v167, -v165, v14, v163
  v_fmac_f32 v164, v166, v160
  v_fmac_f32 v165, v167, v160
  v_cvt_pk_bf16_f32 v6, v164, v165
  v_sub_f32 v162, v150, v12
  v_sub_f32 v163, v151, v12
  v_cvt_pk_bf16_f32 v164, v162, v163
  v_lshlrev_b32 v162, 16, v164
  v_and_b32 v163, 0xffff0000, v164
  v_mul_f32 v164, v162, v160
  v_mul_f32 v165, v163, v160
  v_fma_f32 v166, -v164, v14, v162
  v_fma_f32 v167, -v165, v14, v163
  v_fmac_f32 v164, v166, v160
  v_fmac_f32 v165, v167, v160
  v_cvt_pk_bf16_f32 v7, v164, v165
  v_sub_f32 v162, v152, v13
  v_sub_f32 v163, v153, v13
  v_cvt_pk_bf16_f32 v164, v162, v163
  v_lshlrev_b32 v162, 16, v164
  v_and_b32 v163, 0xffff0000, v164
  v_mul_f32 v164, v162, v161
  v_mul_f32 v165, v163, v161
  v_fma_f32 v166, -v164, v15, v162
  v_fma_f32 v167, -v165, v15, v163
  v_fmac_f32 v164, v166, v161
  v_fmac_f32 v165, v167, v161
  v_cvt_pk_bf16_f32 v8, v164, v165
  v_sub_f32 v162, v154, v13
  v_sub_f32 v163, v155, v13
  v_cvt_pk_bf16_f32 v164, v162, v163
  v_lshlrev_b32 v162, 16, v164
  v_and_b32 v163, 0xffff0000, v164
  v_mul_f32 v164, v162, v161
  v_mul_f32 v165, v163, v161
  v_fma_f32 v166, -v164, v15, v162
  v_fma_f32 v167, -v165, v15, v163
  v_fmac_f32 v164, v166, v161
  v_fmac_f32 v165, v167, v161
  v_cvt_pk_bf16_f32 v9, v164, v165
  v_sub_f32 v162, v156, v13
  v_sub_f32 v163, v157, v13
  v_cvt_pk_bf16_f32 v164, v162, v163
  v_lshlrev_b32 v162, 16, v164
  v_and_b32 v163, 0xffff0000, v164
  v_mul_f32 v164, v162, v161
  v_mul_f32 v165, v163, v161
  v_fma_f32 v166, -v164, v15, v162
  v_fma_f32 v167, -v165, v15, v163
  v_fmac_f32 v164, v166, v161
  v_fmac_f32 v165, v167, v161
  v_cvt_pk_bf16_f32 v10, v164, v165
  v_sub_f32 v162, v158, v13
  v_sub_f32 v163, v159, v13
  v_cvt_pk_bf16_f32 v164, v162, v163
  v_lshlrev_b32 v162, 16, v164
  v_and_b32 v163, 0xffff0000, v164
  v_mul_f32 v164, v162, v161
  v_mul_f32 v165, v163, v161
  v_fma_f32 v166, -v164, v15, v162
  v_fma_f32 v167, -v165, v15, v163
  v_fmac_f32 v164, v166, v161
  v_fmac_f32 v165, v167, v161
  v_cvt_pk_bf16_f32 v11, v164, v165
  ds_write_b128 v1, v[4:7] offset:2048
  ds_write_b128 v1, v[8:11] offset:3072
  v_bfe_u32 v160, v0, 3, 1
  v_lshlrev_b32 v160, 10, v160
  v_lshlrev_b32 v161, 1, v2
  s_lshl_b32 s33, s37, 8
  v_add3_u32 v160, v160, v161, s33
  s_waitcnt lgkmcnt(0)
  v_and_b32 v5, 7, v0
  v_mov_b32 v6, 0xffff
  v_mov_b32 v7, 0xffff0000
  v_mov_b32 v8, 0
  v_cmp_eq_u32 vcc, 0, v5
  s_nop 1
  v_cndmask_b32 v8, v8, v6, vcc
  v_cmp_eq_u32 vcc, 1, v5
  s_nop 1
  v_cndmask_b32 v8, v8, v7, vcc
  v_mov_b32 v9, 0
  v_cmp_eq_u32 vcc, 2, v5
  s_nop 1
  v_cndmask_b32 v9, v9, v6, vcc
  v_cmp_eq_u32 vcc, 3, v5
  s_nop 1
  v_cndmask_b32 v9, v9, v7, vcc
  v_mov_b32 v10, 0
  v_cmp_eq_u32 vcc, 4, v5
  s_nop 1
  v_cndmask_b32 v10, v10, v6, vcc
  v_cmp_eq_u32 vcc, 5, v5
  s_nop 1
  v_cndmask_b32 v10, v10, v7, vcc
  v_mov_b32 v11, 0
  v_cmp_eq_u32 vcc, 6, v5
  s_nop 1
  v_cndmask_b32 v11, v11, v6, vcc
  v_cmp_eq_u32 vcc, 7, v5
  s_nop 1
  v_cndmask_b32 v11, v11, v7, vcc
  v_mov_b32 v6, 0
  global_load_dword v5, v6, s[24:25] sc1
  ds_read_u16 v144, v160 offset:2048
  ds_read_u16 v145, v160 offset:2056
  ds_read_u16 v146, v160 offset:2064
  ds_read_u16 v147, v160 offset:2072
  ds_read_u16 v148, v160 offset:2080
  ds_read_u16 v149, v160 offset:2088
  ds_read_u16 v150, v160 offset:2096
  ds_read_u16 v151, v160 offset:2104
  ds_read_u16 v152, v160 offset:2112
  ds_read_u16 v153, v160 offset:2120
  ds_read_u16 v154, v160 offset:2128
  ds_read_u16 v155, v160 offset:2136
  ds_read_u16 v156, v160 offset:2144
  ds_read_u16 v157, v160 offset:2152
  ds_read_u16 v158, v160 offset:2160
  ds_read_u16 v159, v160 offset:2168
  s_waitcnt lgkmcnt(0)
  s_waitcnt vmcnt(17)
  v_lshl_or_b32 v144, v144, 16, v144
  v_and_b32 v160, v144, v8
  v_and_b32 v161, v144, v9
  v_and_b32 v162, v144, v10
  v_and_b32 v163, v144, v11
  s_nop 1
  v_mfma_f32_16x16x32_bf16 v[12:15], v[16:19], v[160:163], 0
  v_lshl_or_b32 v145, v145, 16, v145
  v_and_b32 v164, v145, v8
  v_and_b32 v165, v145, v9
  v_and_b32 v166, v145, v10
  v_and_b32 v167, v145, v11
  s_nop 1
  v_mfma_f32_16x16x32_bf16 v[12:15], v[20:23], v[164:167], v[12:15]
  v_lshl_or_b32 v146, v146, 16, v146
  v_and_b32 v160, v146, v8
  v_and_b32 v161, v146, v9
  v_and_b32 v162, v146, v10
  v_and_b32 v163, v146, v11
  s_nop 1
  v_mfma_f32_16x16x32_bf16 v[12:15], v[24:27], v[160:163], v[12:15]
  v_lshl_or_b32 v147, v147, 16, v147
  v_and_b32 v164, v147, v8
  v_and_b32 v165, v147, v9
  v_and_b32 v166, v147, v10
  v_and_b32 v167, v147, v11
  s_nop 1
  v_mfma_f32_16x16x32_bf16 v[12:15], v[28:31], v[164:167], v[12:15]
  v_lshl_or_b32 v148, v148, 16, v148
  v_and_b32 v160, v148, v8
  v_and_b32 v161, v148, v9
  v_and_b32 v162, v148, v10
  v_and_b32 v163, v148, v11
  s_nop 1
  v_mfma_f32_16x16x32_bf16 v[12:15], v[32:35], v[160:163], v[12:15]
  v_lshl_or_b32 v149, v149, 16, v149
  v_and_b32 v164, v149, v8
  v_and_b32 v165, v149, v9
  v_and_b32 v166, v149, v10
  v_and_b32 v167, v149, v11
  s_nop 1
  v_mfma_f32_16x16x32_bf16 v[12:15], v[36:39], v[164:167], v[12:15]
  v_lshl_or_b32 v150, v150, 16, v150
  v_and_b32 v160, v150, v8
  v_and_b32 v161, v150, v9
  v_and_b32 v162, v150, v10
  v_and_b32 v163, v150, v11
  s_nop 1
  v_mfma_f32_16x16x32_bf16 v[12:15], v[40:43], v[160:163], v[12:15]
  v_lshl_or_b32 v151, v151, 16, v151
  v_and_b32 v164, v151, v8
  v_and_b32 v165, v151, v9
  v_and_b32 v166, v151, v10
  v_and_b32 v167, v151, v11
  s_nop 1
  v_mfma_f32_16x16x32_bf16 v[12:15], v[44:47], v[164:167], v[12:15]
  v_lshl_or_b32 v152, v152, 16, v152
  v_and_b32 v160, v152, v8
  v_and_b32 v161, v152, v9
  v_and_b32 v162, v152, v10
  v_and_b32 v163, v152, v11
  s_nop 1
  v_mfma_f32_16x16x32_bf16 v[12:15], v[48:51], v[160:163], v[12:15]
  v_lshl_or_b32 v153, v153, 16, v153
  v_and_b32 v164, v153, v8
  v_and_b32 v165, v153, v9
  v_and_b32 v166, v153, v10
  v_and_b32 v167, v153, v11
  s_nop 1
  v_mfma_f32_16x16x32_bf16 v[12:15], v[52:55], v[164:167], v[12:15]
  v_lshl_or_b32 v154, v154, 16, v154
  v_and_b32 v160, v154, v8
  v_and_b32 v161, v154, v9
  v_and_b32 v162, v154, v10
  v_and_b32 v163, v154, v11
  s_nop 1
  v_mfma_f32_16x16x32_bf16 v[12:15], v[56:59], v[160:163], v[12:15]
  v_lshl_or_b32 v155, v155, 16, v155
  v_and_b32 v164, v155, v8
  v_and_b32 v165, v155, v9
  v_and_b32 v166, v155, v10
  v_and_b32 v167, v155, v11
  s_nop 1
  v_mfma_f32_16x16x32_bf16 v[12:15], v[60:63], v[164:167], v[12:15]
  v_lshl_or_b32 v156, v156, 16, v156
  v_and_b32 v160, v156, v8
  v_and_b32 v161, v156, v9
  v_and_b32 v162, v156, v10
  v_and_b32 v163, v156, v11
  s_nop 1
  v_mfma_f32_16x16x32_bf16 v[12:15], v[64:67], v[160:163], v[12:15]
  v_lshl_or_b32 v157, v157, 16, v157
  v_and_b32 v164, v157, v8
  v_and_b32 v165, v157, v9
  v_and_b32 v166, v157, v10
  v_and_b32 v167, v157, v11
  s_nop 1
  v_mfma_f32_16x16x32_bf16 v[12:15], v[68:71], v[164:167], v[12:15]
  v_lshl_or_b32 v158, v158, 16, v158
  v_and_b32 v160, v158, v8
  v_and_b32 v161, v158, v9
  v_and_b32 v162, v158, v10
  v_and_b32 v163, v158, v11
  s_nop 1
  v_mfma_f32_16x16x32_bf16 v[12:15], v[72:75], v[160:163], v[12:15]
  v_lshl_or_b32 v159, v159, 16, v159
  v_and_b32 v164, v159, v8
  v_and_b32 v165, v159, v9
  v_and_b32 v166, v159, v10
  v_and_b32 v167, v159, v11
  s_nop 1
  v_mfma_f32_16x16x32_bf16 v[12:15], v[76:79], v[164:167], v[12:15]
  v_bfe_u32 v160, v0, 3, 1
  v_lshlrev_b32 v160, 10, v160
  v_lshlrev_b32 v161, 1, v2
  v_add3_u32 v160, v160, v161, s33
  ds_read_u16 v144, v160 offset:2176
  ds_read_u16 v145, v160 offset:2184
  ds_read_u16 v146, v160 offset:2192
  ds_read_u16 v147, v160 offset:2200
  ds_read_u16 v148, v160 offset:2208
  ds_read_u16 v149, v160 offset:2216
  ds_read_u16 v150, v160 offset:2224
  ds_read_u16 v151, v160 offset:2232
  ds_read_u16 v152, v160 offset:2240
  ds_read_u16 v153, v160 offset:2248
  ds_read_u16 v154, v160 offset:2256
  ds_read_u16 v155, v160 offset:2264
  ds_read_u16 v156, v160 offset:2272
  ds_read_u16 v157, v160 offset:2280
  ds_read_u16 v158, v160 offset:2288
  ds_read_u16 v159, v160 offset:2296
  s_waitcnt lgkmcnt(0)
  s_waitcnt vmcnt(1)
  v_lshl_or_b32 v144, v144, 16, v144
  v_and_b32 v160, v144, v8
  v_and_b32 v161, v144, v9
  v_and_b32 v162, v144, v10
  v_and_b32 v163, v144, v11
  s_nop 1
  v_mfma_f32_16x16x32_bf16 v[12:15], v[80:83], v[160:163], v[12:15]
  v_lshl_or_b32 v145, v145, 16, v145
  v_and_b32 v164, v145, v8
  v_and_b32 v165, v145, v9
  v_and_b32 v166, v145, v10
  v_and_b32 v167, v145, v11
  s_nop 1
  v_mfma_f32_16x16x32_bf16 v[12:15], v[84:87], v[164:167], v[12:15]
  v_lshl_or_b32 v146, v146, 16, v146
  v_and_b32 v160, v146, v8
  v_and_b32 v161, v146, v9
  v_and_b32 v162, v146, v10
  v_and_b32 v163, v146, v11
  s_nop 1
  v_mfma_f32_16x16x32_bf16 v[12:15], v[88:91], v[160:163], v[12:15]
  v_lshl_or_b32 v147, v147, 16, v147
  v_and_b32 v164, v147, v8
  v_and_b32 v165, v147, v9
  v_and_b32 v166, v147, v10
  v_and_b32 v167, v147, v11
  s_nop 1
  v_mfma_f32_16x16x32_bf16 v[12:15], v[92:95], v[164:167], v[12:15]
  v_lshl_or_b32 v148, v148, 16, v148
  v_and_b32 v160, v148, v8
  v_and_b32 v161, v148, v9
  v_and_b32 v162, v148, v10
  v_and_b32 v163, v148, v11
  s_nop 1
  v_mfma_f32_16x16x32_bf16 v[12:15], v[96:99], v[160:163], v[12:15]
  v_lshl_or_b32 v149, v149, 16, v149
  v_and_b32 v164, v149, v8
  v_and_b32 v165, v149, v9
  v_and_b32 v166, v149, v10
  v_and_b32 v167, v149, v11
  s_nop 1
  v_mfma_f32_16x16x32_bf16 v[12:15], v[100:103], v[164:167], v[12:15]
  v_lshl_or_b32 v150, v150, 16, v150
  v_and_b32 v160, v150, v8
  v_and_b32 v161, v150, v9
  v_and_b32 v162, v150, v10
  v_and_b32 v163, v150, v11
  s_nop 1
  v_mfma_f32_16x16x32_bf16 v[12:15], v[104:107], v[160:163], v[12:15]
  v_lshl_or_b32 v151, v151, 16, v151
  v_and_b32 v164, v151, v8
  v_and_b32 v165, v151, v9
  v_and_b32 v166, v151, v10
  v_and_b32 v167, v151, v11
  s_nop 1
  v_mfma_f32_16x16x32_bf16 v[12:15], v[108:111], v[164:167], v[12:15]
  v_lshl_or_b32 v152, v152, 16, v152
  v_and_b32 v160, v152, v8
  v_and_b32 v161, v152, v9
  v_and_b32 v162, v152, v10
  v_and_b32 v163, v152, v11
  s_nop 1
  v_mfma_f32_16x16x32_bf16 v[12:15], v[112:115], v[160:163], v[12:15]
  v_lshl_or_b32 v153, v153, 16, v153
  v_and_b32 v164, v153, v8
  v_and_b32 v165, v153, v9
  v_and_b32 v166, v153, v10
  v_and_b32 v167, v153, v11
  s_nop 1
  v_mfma_f32_16x16x32_bf16 v[12:15], v[116:119], v[164:167], v[12:15]
  v_lshl_or_b32 v154, v154, 16, v154
  v_and_b32 v160, v154, v8
  v_and_b32 v161, v154, v9
  v_and_b32 v162, v154, v10
  v_and_b32 v163, v154, v11
  s_nop 1
  v_mfma_f32_16x16x32_bf16 v[12:15], v[120:123], v[160:163], v[12:15]
  v_lshl_or_b32 v155, v155, 16, v155
  v_and_b32 v164, v155, v8
  v_and_b32 v165, v155, v9
  v_and_b32 v166, v155, v10
  v_and_b32 v167, v155, v11
  s_nop 1
  v_mfma_f32_16x16x32_bf16 v[12:15], v[124:127], v[164:167], v[12:15]
  v_lshl_or_b32 v156, v156, 16, v156
  v_and_b32 v160, v156, v8
  v_and_b32 v161, v156, v9
  v_and_b32 v162, v156, v10
  v_and_b32 v163, v156, v11
  s_nop 1
  v_mfma_f32_16x16x32_bf16 v[12:15], v[128:131], v[160:163], v[12:15]
  v_lshl_or_b32 v157, v157, 16, v157
  v_and_b32 v164, v157, v8
  v_and_b32 v165, v157, v9
  v_and_b32 v166, v157, v10
  v_and_b32 v167, v157, v11
  s_nop 1
  v_mfma_f32_16x16x32_bf16 v[12:15], v[132:135], v[164:167], v[12:15]
  v_lshl_or_b32 v158, v158, 16, v158
  v_and_b32 v160, v158, v8
  v_and_b32 v161, v158, v9
  v_and_b32 v162, v158, v10
  v_and_b32 v163, v158, v11
  s_nop 1
  v_mfma_f32_16x16x32_bf16 v[12:15], v[136:139], v[160:163], v[12:15]
  v_lshl_or_b32 v159, v159, 16, v159
  v_and_b32 v164, v159, v8
  v_and_b32 v165, v159, v9
  v_and_b32 v166, v159, v10
  v_and_b32 v167, v159, v11
  s_nop 1
  v_mfma_f32_16x16x32_bf16 v[12:15], v[140:143], v[164:167], v[12:15]
  s_mov_b32 s46, 4000
  s_waitcnt vmcnt(0)
  v_readfirstlane_b32 s47, v5
  s_cmp_lg_u32 s47, 0
  s_cbranch_scc1 L_nn_done_33
L_nn_32:
  global_load_dword v5, v6, s[24:25] sc1
  s_waitcnt vmcnt(0)
  v_readfirstlane_b32 s47, v5
  s_cmp_lg_u32 s47, 0
  s_cbranch_scc1 L_nn_done_33
  s_sleep 8
  s_sub_u32 s46, s46, 1
  s_cmp_lg_u32 s46, 0
  s_cbranch_scc1 L_nn_32
L_nn_done_33:
  s_lshl_b32 s33, s37, 5
  s_add_u32 s33, s33, s36
  s_lshl_b32 s33, s33, 11
  v_add_u32 v160, s33, v1
  v_mov_b32 v20, v15
  v_mov_b32 v21, s47
  v_mov_b32 v22, s47
  v_mov_b32 v23, s47
  v_mov_b32 v15, s47
  global_store_dwordx4 v160, v[12:15], s[26:27] offset:0 sc1
  global_store_dwordx4 v160, v[20:23], s[26:27] offset:1024 sc1
  v_mov_b32 v16, -1
  v_mov_b32 v17, -1
  v_mov_b32 v18, -1
  v_mov_b32 v19, -1
  s_lshl_b32 s33, s32, 4
  s_add_u32 s33, s33, s31
  s_lshl_b32 s34, s33, 11
  s_add_u32 s34, s34, 0x80000
  v_add_u32 v160, s34, v1
  global_store_dwordx4 v160, v[16:19], s[26:27] sc1
  global_store_dwordx4 v160, v[16:19], s[26:27] offset:1024 sc1
  v_add_u32 v161, s38, v1
  s_mov_b64 exec, 0xff
  global_store_dwordx4 v161, v[16:19], s[26:27] sc1
  s_mov_b64 exec, -1
  s_cmp_lg_u32 s51, 1
  s_cbranch_scc1 L_skip_acs_34
  s_lshl_b32 s34, s50, 1
  s_add_u32 s34, s34, 0x110000
  v_lshrrev_b32 v162, 2, v0
  v_mul_u32_u24 v162, 3584, v162
  v_and_b32 v163, 3, v0
  v_lshlrev_b32 v163, 4, v163
  v_add3_u32 v162, v162, v163, s34
  s_mov_b64 exec, 0xff
  global_store_dwordx4 v162, v[16:19], s[26:27] sc1
  s_mov_b64 exec, -1
L_skip_acs_34:
  s_branch L_front_done_31
L_noprod_30:
  s_barrier
  global_load_dwordx4 v[8:11], v1, s[4:5]
  global_load_dwordx4 v[12:15], v1, s[4:5] offset:1024
  v_mov_b32 v16, -1
  v_mov_b32 v17, -1
  v_mov_b32 v18, -1
  v_mov_b32 v19, -1
  s_lshl_b32 s33, s32, 4
  s_add_u32 s33, s33, s31
  s_lshl_b32 s34, s33, 11
  s_add_u32 s34, s34, 0x80000
  v_add_u32 v160, s34, v1
  global_store_dwordx4 v160, v[16:19], s[26:27] sc1
  global_store_dwordx4 v160, v[16:19], s[26:27] offset:1024 sc1
  v_add_u32 v161, s38, v1
  s_mov_b64 exec, 0xff
  global_store_dwordx4 v161, v[16:19], s[26:27] sc1
  s_mov_b64 exec, -1
  s_cmp_lg_u32 s51, 1
  s_cbranch_scc1 L_skip_acs_35
  s_lshl_b32 s34, s50, 1
  s_add_u32 s34, s34, 0x110000
  v_lshrrev_b32 v162, 2, v0
  v_mul_u32_u24 v162, 3584, v162
  v_and_b32 v163, 3, v0
  v_lshlrev_b32 v163, 4, v163
  v_add3_u32 v162, v162, v163, s34
  s_mov_b64 exec, 0xff
  global_store_dwordx4 v162, v[16:19], s[26:27] sc1
  s_mov_b64 exec, -1
L_skip_acs_35:
  v_mov_b32 v6, 0
  s_mov_b32 s46, 4000
L_nn_36:
  global_load_dword v5, v6, s[24:25] sc1
  s_waitcnt vmcnt(0)
  v_readfirstlane_b32 s47, v5
  s_cmp_lg_u32 s47, 0
  s_cbranch_scc1 L_nn_done_37
  s_sleep 8
  s_sub_u32 s46, s46, 1
  s_cmp_lg_u32 s46, 0
  s_cbranch_scc1 L_nn_36
L_nn_done_37:
  ds_write_b128 v1, v[8:11] offset:0
  ds_write_b128 v1, v[12:15] offset:1024
L_front_done_31:
  v_bfe_u32 v4, v0, 2, 2
  v_and_b32 v5, 3, v0
  v_lshlrev_b32 v4, 16, v4
  v_lshlrev_b32 v5, 11, v5
  s_lshl_b32 s33, s29, 13
  v_add3_u32 v4, v4, v5, s33
  s_mov_b32 s46, 4000
  global_load_dword v100, v4, s[26:27] offset:2044 sc1
L_ql_39:
  s_waitcnt vmcnt(0)
  v_cmp_ne_u32 vcc, s47, v100
  s_cmp_lg_u64 vcc, -1
  s_cbranch_scc1 L_ql_ok0_40
  s_sleep 8
  global_load_dword v100, v4, s[26:27] offset:2044 sc1
  s_sub_u32 s46, s46, 1
  s_cmp_lg_u32 s46, 0
  s_cbranch_scc1 L_ql_39
  s_branch L_ql_done_38
L_ql_ok0_40:
L_ql_done_38:
  v_lshrrev_b32 v4, 5, v0
  v_bfe_u32 v5, v0, 3, 2
  v_and_b32 v6, 7, v0
  s_lshl_b32 s34, s30, 7
  s_add_u32 s33, s33, s34
  v_lshlrev_b32 v7, 11, v4
  v_lshlrev_b32 v8, 8, v5
  v_lshlrev_b32 v9, 4, v6
  v_add3_u32 v7, v7, v8, v9
  v_add_u32 v7, s33, v7
  v_add_u32 v8, 4096, v7
  v_add_u32 v9, 65536, v7
  v_add_u32 v10, 69632, v7
  v_add_u32 v11, 131072, v7
  v_add_u32 v12, 135168, v7
  v_add_u32 v13, 196608, v7
  v_add_u32 v14, 200704, v7
  s_mov_b32 s46, 4000
L_qg_41:
  global_load_dwordx4 v[24:27], v7, s[26:27] offset:0 sc1
  global_load_dwordx4 v[28:31], v7, s[26:27] offset:1024 sc1
  global_load_dwordx4 v[32:35], v8, s[26:27] offset:0 sc1
  global_load_dwordx4 v[36:39], v8, s[26:27] offset:1024 sc1
  global_load_dwordx4 v[40:43], v9, s[26:27] offset:0 sc1
  global_load_dwordx4 v[44:47], v9, s[26:27] offset:1024 sc1
  global_load_dwordx4 v[48:51], v10, s[26:27] offset:0 sc1
  global_load_dwordx4 v[52:55], v10, s[26:27] offset:1024 sc1
  global_load_dwordx4 v[56:59], v11, s[26:27] offset:0 sc1
  global_load_dwordx4 v[60:63], v11, s[26:27] offset:1024 sc1
  global_load_dwordx4 v[64:67], v12, s[26:27] offset:0 sc1
  global_load_dwordx4 v[68:71], v12, s[26:27] offset:1024 sc1
  global_load_dwordx4 v[72:75], v13, s[26:27] offset:0 sc1
  global_load_dwordx4 v[76:79], v13, s[26:27] offset:1024 sc1
  global_load_dwordx4 v[80:83], v14, s[26:27] offset:0 sc1
  global_load_dwordx4 v[84:87], v14, s[26:27] offset:1024 sc1
  s_waitcnt vmcnt(0)
  v_xor_b32 v16, s47, v27
  v_xor_b32 v17, s47, v31
  v_or_b32 v16, v16, v17
  v_xor_b32 v17, s47, v35
  v_or_b32 v16, v16, v17
  v_xor_b32 v17, s47, v39
  v_or_b32 v16, v16, v17
  v_xor_b32 v17, s47, v43
  v_or_b32 v16, v16, v17
  v_xor_b32 v17, s47, v47
  v_or_b32 v16, v16, v17
  v_xor_b32 v17, s47, v51
  v_or_b32 v16, v16, v17
  v_xor_b32 v17, s47, v55
  v_or_b32 v16, v16, v17
  v_xor_b32 v17, s47, v59
  v_or_b32 v16, v16, v17
  v_xor_b32 v17, s47, v63
  v_or_b32 v16, v16, v17
  v_xor_b32 v17, s47, v67
  v_or_b32 v16, v16, v17
  v_xor_b32 v17, s47, v71
  v_or_b32 v16, v16, v17
  v_xor_b32 v17, s47, v75
  v_or_b32 v16, v16, v17
  v_xor_b32 v17, s47, v79
  v_or_b32 v16, v16, v17
  v_xor_b32 v17, s47, v83
  v_or_b32 v16, v16, v17
  v_xor_b32 v17, s47, v87
  v_or_b32 v16, v16, v17
  v_cmp_ne_u32 vcc, 0, v16
  s_cbranch_vccz L_qg_done_42
  s_sub_u32 s46, s46, 1
  s_cmp_lg_u32 s46, 0
  s_cbranch_scc1 L_qg_41
L_qg_done_42:
  v_mov_b32 v27, v28
  v_mov_b32 v35, v36
  v_mov_b32 v43, v44
  v_mov_b32 v51, v52
  v_mov_b32 v59, v60
  v_mov_b32 v67, v68
  v_mov_b32 v75, v76
  v_mov_b32 v83, v84
  v_add_f32 v24, v24, v40
  v_add_f32 v25, v25, v41
  v_add_f32 v26, v26, v42
  v_add_f32 v27, v27, v43
  v_add_f32 v32, v32, v48
  v_add_f32 v33, v33, v49
  v_add_f32 v34, v34, v50
  v_add_f32 v35, v35, v51
  v_add_f32 v24, v24, v56
  v_add_f32 v25, v25, v57
  v_add_f32 v26, v26, v58
  v_add_f32 v27, v27, v59
  v_add_f32 v32, v32, v64
  v_add_f32 v33, v33, v65
  v_add_f32 v34, v34, v66
  v_add_f32 v35, v35, v67
  v_add_f32 v24, v24, v72
  v_add_f32 v25, v25, v73
  v_add_f32 v26, v26, v74
  v_add_f32 v27, v27, v75
  v_add_f32 v32, v32, v80
  v_add_f32 v33, v33, v81
  v_add_f32 v34, v34, v82
  v_add_f32 v35, v35, v83
  v_lshlrev_b32 v7, 8, v4
  v_lshlrev_b32 v8, 6, v5
  v_lshlrev_b32 v9, 1, v6
  v_add3_u32 v7, v7, v8, v9
  v_cvt_pk_bf16_f32 v16, v24, v24
  ds_write_b16 v7, v16 offset:4096
  v_cvt_pk_bf16_f32 v17, v25, v25
  ds_write_b16 v7, v17 offset:4112
  v_cvt_pk_bf16_f32 v18, v26, v26
  ds_write_b16 v7, v18 offset:4128
  v_cvt_pk_bf16_f32 v19, v27, v27
  ds_write_b16 v7, v19 offset:4144
  v_cvt_pk_bf16_f32 v20, v32, v32
  ds_write_b16 v7, v20 offset:4608
  v_cvt_pk_bf16_f32 v21, v33, v33
  ds_write_b16 v7, v21 offset:4624
  v_cvt_pk_bf16_f32 v22, v34, v34
  ds_write_b16 v7, v22 offset:4640
  v_cvt_pk_bf16_f32 v23, v35, v35
  ds_write_b16 v7, v23 offset:4656
  s_waitcnt lgkmcnt(0)
  v_mov_b32 v164, 0
  v_mov_b32 v165, 1
  ds_write_b32 v164, v165 offset:5504
  v_and_b32 v4, 31, v0
  v_lshlrev_b32 v4, 3, v4
  s_lshl_b32 s33, s32, 10
  s_lshl_b32 s34, s31, 6
  s_add_u32 s33, s33, 0x40000
  s_add_u32 s34, s34, s33
  v_add_u32 v6, s34, v1
  v_add_u32 v7, s33, v1
  s_lshl_b32 s33, s2, 2
  s_add_u32 s33, s33, 0x120000
  v_mov_b32 v8, s33
  v_mov_b32 v9, s47
  s_mov_b32 s46, 64000
L_wc_43:
  ds_read_b32 v166, v164 offset:5508
  s_waitcnt lgkmcnt(0)
  v_readfirstlane_b32 s48, v166
  s_cmp_eq_u32 s48, 512
  s_cbranch_scc1 L_wc_done_44
  s_sub_u32 s46, s46, 1
  s_cmp_lg_u32 s46, 0
  s_cbranch_scc1 L_wc_43
L_wc_done_44:
  ds_read_b64 v[12:13], v4 offset:5120
  s_waitcnt lgkmcnt(0)
  v_mov_b32 v14, v12
  s_nop 1
  v_max_f32_dpp v14, v14, v14 row_ror:4 row_mask:0xf bank_mask:0xf
  s_nop 1
  v_max_f32_dpp v14, v14, v14 row_ror:8 row_mask:0xf bank_mask:0xf
  v_mov_b32 v15, v14
  s_nop 1
  v_permlane16_swap_b32 v14, v15
  v_max_f32 v14, v14, v15
  v_sub_f32 v12, v12, v14
  v_mul_f32 v12, s44, v12
  v_exp_f32 v12, v12
  s_nop 0
  v_mul_f32 v13, v13, v12
  s_nop 1
  v_add_f32_dpp v13, v13, v13 row_ror:4 row_mask:0xf bank_mask:0xf
  s_nop 1
  v_add_f32_dpp v13, v13, v13 row_ror:8 row_mask:0xf bank_mask:0xf
  v_mov_b32 v15, v13
  s_nop 1
  v_permlane16_swap_b32 v13, v15
  v_add_f32 v13, v13, v15
  v_mov_b32 v12, v14
  v_mov_b32 v14, s47
  v_mov_b32 v15, s47
  s_mov_b64 exec, 0xf
  global_store_dwordx4 v6, v[12:15], s[26:27] sc1
  s_mov_b64 exec, 0x1
  global_store_dword v8, v9, s[26:27] sc1
  s_mov_b64 exec, -1
  s_mov_b32 s46, 4000
  global_load_dwordx4 v[100:103], v7, s[26:27] sc1
L_st_46:
  s_waitcnt vmcnt(0)
  v_cmp_ne_u32 vcc, s47, v103
  s_cbranch_vccz L_st_ok0_47
  s_sleep 8
  global_load_dwordx4 v[100:103], v7, s[26:27] sc1
  s_sub_u32 s46, s46, 1
  s_cmp_lg_u32 s46, 0
  s_cbranch_scc1 L_st_46
  s_branch L_st_done_45
L_st_ok0_47:
  v_mov_b32 v12, v100
  v_mov_b32 v13, v101
  v_mov_b32 v14, v102
  v_mov_b32 v15, v103
L_st_done_45:
  v_mov_b32 v14, v12
  s_nop 1
  v_max_f32_dpp v14, v14, v14 row_ror:4 row_mask:0xf bank_mask:0xf
  s_nop 1
  v_max_f32_dpp v14, v14, v14 row_ror:8 row_mask:0xf bank_mask:0xf
  v_mov_b32 v15, v14
  s_nop 1
  v_permlane16_swap_b32 v14, v15
  v_max_f32 v14, v14, v15
  v_mov_b32 v15, v14
  s_nop 1
  v_permlane32_swap_b32 v14, v15
  v_max_f32 v14, v14, v15
  v_sub_f32 v12, v12, v14
  v_mul_f32 v12, s44, v12
  v_exp_f32 v12, v12
  s_nop 0
  v_mul_f32 v13, v13, v12
  s_nop 1
  v_add_f32_dpp v13, v13, v13 row_ror:4 row_mask:0xf bank_mask:0xf
  s_nop 1
  v_add_f32_dpp v13, v13, v13 row_ror:8 row_mask:0xf bank_mask:0xf
  v_mov_b32 v15, v13
  s_nop 1
  v_permlane16_swap_b32 v13, v15
  v_add_f32 v13, v13, v15
  v_mov_b32 v15, v13
  s_nop 1
  v_permlane32_swap_b32 v13, v15
  v_add_f32 v13, v13, v15
  v_rcp_f32 v15, v13
  s_nop 0
  v_fma_f32 v12, -v13, v15, 1.0
  v_fmac_f32 v15, v12, v15
  v_mov_b32 v12, v14
  v_mov_b32 v13, v15
  v_and_b32 v4, 3, v0
  v_lshlrev_b32 v4, 3, v4
  ds_write_b64 v4, v[12:13] offset:5376
  s_waitcnt lgkmcnt(0)
  ds_write_b32 v164, v165 offset:5512
  s_cmp_eq_u32 s51, 0
  s_cbranch_scc1 L_nofl_48
  v_add_u32 v6, 0x120000, v1
  s_mov_b32 s46, 4000
  global_load_dwordx4 v[100:103], v6, s[26:27] sc1
L_fl_50:
  s_waitcnt vmcnt(0)
  v_xor_b32 v16, s47, v100
  v_xor_b32 v17, s47, v101
  v_or_b32 v16, v16, v17
  v_xor_b32 v17, s47, v102
  v_or_b32 v16, v16, v17
  v_xor_b32 v17, s47, v103
  v_or_b32 v16, v16, v17
  v_cmp_ne_u32 vcc, 0, v16
  s_cbranch_vccz L_fl_ok0_51
  s_sleep 8
  global_load_dwordx4 v[100:103], v6, s[26:27] sc1
  s_sub_u32 s46, s46, 1
  s_cmp_lg_u32 s46, 0
  s_cbranch_scc1 L_fl_50
  s_branch L_fl_done_49
L_fl_ok0_51:
L_fl_done_49:
L_nofl_48:
  s_lshl_b32 s33, s32, 15
  s_lshl_b32 s34, s31, 11
  s_add_u32 s33, s33, s34
  s_add_u32 s33, s33, 0x80000
  v_add_u32 v6, s33, v1
  s_lshl_b32 s33, s32, 8
  s_add_u32 s33, s33, 0x121000
  s_lshl_b32 s34, s31, 2
  s_add_u32 s34, s34, s33
  v_mov_b32 v8, s34
  v_lshlrev_b32 v7, 2, v3
  v_add_u32 v7, s33, v7
  v_mov_b32 v9, s47
  s_barrier
  ds_read_b128 v[16:19], v1 offset:5632
  ds_read_b128 v[20:23], v1 offset:7680
  ds_read_b128 v[24:27], v1 offset:9728
  ds_read_b128 v[28:31], v1 offset:11776
  ds_read_b128 v[32:35], v1 offset:13824
  ds_read_b128 v[36:39], v1 offset:15872
  ds_read_b128 v[40:43], v1 offset:17920
  ds_read_b128 v[44:47], v1 offset:19968
  ds_read_b128 v[48:51], v1 offset:6656
  ds_read_b128 v[52:55], v1 offset:8704
  ds_read_b128 v[56:59], v1 offset:10752
  ds_read_b128 v[60:63], v1 offset:12800
  ds_read_b128 v[64:67], v1 offset:14848
  ds_read_b128 v[68:71], v1 offset:16896
  ds_read_b128 v[72:75], v1 offset:18944
  ds_read_b128 v[76:79], v1 offset:20992
  s_waitcnt lgkmcnt(8)
  v_add_f32 v16, v16, v20
  v_add_f32 v24, v24, v28
  v_add_f32 v32, v32, v36
  v_add_f32 v40, v40, v44
  v_add_f32 v17, v17, v21
  v_add_f32 v25, v25, v29
  v_add_f32 v33, v33, v37
  v_add_f32 v41, v41, v45
  v_add_f32 v18, v18, v22
  v_add_f32 v26, v26, v30
  v_add_f32 v34, v34, v38
  v_add_f32 v42, v42, v46
  v_add_f32 v19, v19, v23
  v_add_f32 v27, v27, v31
  v_add_f32 v35, v35, v39
  v_add_f32 v43, v43, v47
  v_add_f32 v16, v16, v24
  v_add_f32 v32, v32, v40
  v_add_f32 v17, v17, v25
  v_add_f32 v33, v33, v41
  v_add_f32 v18, v18, v26
  v_add_f32 v34, v34, v42
  v_add_f32 v19, v19, v27
  v_add_f32 v35, v35, v43
  v_add_f32 v16, v16, v32
  v_min_u32 v16, 0xfffffffe, v16
  v_add_f32 v17, v17, v33
  v_min_u32 v17, 0xfffffffe, v17
  v_add_f32 v18, v18, v34
  v_min_u32 v18, 0xfffffffe, v18
  v_add_f32 v19, v19, v35
  v_min_u32 v19, 0xfffffffe, v19
  global_store_dwordx4 v6, v[16:19], s[26:27] offset:0 sc1
  s_waitcnt lgkmcnt(0)
  v_add_f32 v48, v48, v52
  v_add_f32 v56, v56, v60
  v_add_f32 v64, v64, v68
  v_add_f32 v72, v72, v76
  v_add_f32 v49, v49, v53
  v_add_f32 v57, v57, v61
  v_add_f32 v65, v65, v69
  v_add_f32 v73, v73, v77
  v_add_f32 v50, v50, v54
  v_add_f32 v58, v58, v62
  v_add_f32 v66, v66, v70
  v_add_f32 v74, v74, v78
  v_add_f32 v51, v51, v55
  v_add_f32 v59, v59, v63
  v_add_f32 v67, v67, v71
  v_add_f32 v75, v75, v79
  v_add_f32 v48, v48, v56
  v_add_f32 v64, v64, v72
  v_add_f32 v49, v49, v57
  v_add_f32 v65, v65, v73
  v_add_f32 v50, v50, v58
  v_add_f32 v66, v66, v74
  v_add_f32 v51, v51, v59
  v_add_f32 v67, v67, v75
  v_add_f32 v48, v48, v64
  v_min_u32 v48, 0xfffffffe, v48
  v_add_f32 v49, v49, v65
  v_min_u32 v49, 0xfffffffe, v49
  v_add_f32 v50, v50, v66
  v_min_u32 v50, 0xfffffffe, v50
  v_add_f32 v51, v51, v67
  v_min_u32 v51, 0xfffffffe, v51
  global_store_dwordx4 v6, v[48:51], s[26:27] offset:1024 sc1
  s_mov_b64 exec, 0x1
  global_store_dword v8, v9, s[26:27] sc1
  s_mov_b64 exec, -1
  s_lshr_b32 s33, s2, 3
  v_lshrrev_b32 v140, 4, v0
  s_cmp_lt_u32 s58, 4
  s_cselect_b32 s34, 3, 2
  v_min_u32 v140, s34, v140
  v_lshlrev_b32 v140, 10, v140
  v_and_b32 v141, 15, v0
  v_mul_u32_u24 v141, 3584, v141
  s_mul_i32 s34, s33, 57344
  s_lshl_b32 s35, s58, 7
  s_add_u32 s34, s34, s35
  v_add3_u32 v140, v140, v141, s34
  global_load_dword v142, v140, s[16:17]
  global_load_dword v143, v140, s[18:19]
  v_min_u32 v140, 55, v0
  v_lshlrev_b32 v140, 10, v140
  s_mul_i32 s34, s33, 57344
  s_add_u32 s34, s34, s35
  v_add_u32 v140, s34, v140
  global_load_dword v144, v140, s[20:21]
  s_mov_b32 s46, 4000
  global_load_dword v100, v7, s[26:27] sc1
L_f1_53:
  s_waitcnt vmcnt(0)
  v_cmp_ne_u32 vcc, s47, v100
  s_cbranch_vccz L_f1_ok0_54
  s_sleep 8
  global_load_dword v100, v7, s[26:27] sc1
  s_sub_u32 s46, s46, 1
  s_cmp_lg_u32 s46, 0
  s_cbranch_scc1 L_f1_53
  s_branch L_f1_done_52
L_f1_ok0_54:
L_f1_done_52:
  s_barrier
  v_and_b32 v4, 31, v0
  v_lshlrev_b32 v4, 2, v4
  v_add_u32 v6, s38, v4
  s_barrier
  ds_read_b32 v16, v4 offset:23040
  ds_read_b32 v17, v4 offset:23168
  ds_read_b32 v18, v4 offset:23296
  ds_read_b32 v19, v4 offset:23424
  ds_read_b32 v20, v4 offset:23552
  ds_read_b32 v21, v4 offset:23680
  ds_read_b32 v22, v4 offset:23808
  ds_read_b32 v23, v4 offset:23936
  s_waitcnt lgkmcnt(0)
  v_add_f32 v16, v16, v17
  v_add_f32 v18, v18, v19
  v_add_f32 v20, v20, v21
  v_add_f32 v22, v22, v23
  v_add_f32 v16, v16, v18
  v_add_f32 v20, v20, v22
  v_add_f32 v16, v16, v20
  v_min_u32 v16, 0xfffffffe, v16
  s_mov_b32 exec_hi, 0
  global_store_dword v6, v16, s[26:27] sc1
  s_mov_b64 exec, -1
  s_cmp_eq_u32 s51, 0
  s_cbranch_scc1 L_end
  s_cmp_eq_u32 s51, 2
  s_cbranch_scc1 L_cdown
  v_lshrrev_b32 v4, 5, v0
  v_and_b32 v5, 31, v0
  v_lshlrev_b32 v10, 8, v4
  v_lshlrev_b32 v11, 2, v5
  v_add_u32 v10, v10, v11
  s_lshl_b32 s33, s50, 1
  s_add_u32 s33, s33, 0x110000
  v_mul_u32_u24 v6, 3584, v4
  v_lshlrev_b32 v11, 1, v5
  v_add3_u32 v6, v6, v11, s33
  s_mov_b32 s39, 0x200
  s_mov_b32 s52, 0x55555555
  s_mov_b32 s53, 0x55555555
  s_barrier
  s_barrier
  ds_read_b32 v16, v10 offset:26368
  ds_read_b32 v24, v10 offset:26496
  ds_read_b32 v17, v10 offset:26880
  ds_read_b32 v25, v10 offset:27008
  ds_read_b32 v18, v10 offset:27392
  ds_read_b32 v26, v10 offset:27520
  ds_read_b32 v19, v10 offset:27904
  ds_read_b32 v27, v10 offset:28032
  ds_read_b32 v20, v10 offset:28416
  ds_read_b32 v28, v10 offset:28544
  ds_read_b32 v21, v10 offset:28928
  ds_read_b32 v29, v10 offset:29056
  ds_read_b32 v22, v10 offset:29440
  ds_read_b32 v30, v10 offset:29568
  ds_read_b32 v23, v10 offset:29952
  ds_read_b32 v31, v10 offset:30080
  s_waitcnt lgkmcnt(0)
  v_add_f32 v16, v16, v17
  v_add_f32 v18, v18, v19
  v_add_f32 v20, v20, v21
  v_add_f32 v22, v22, v23
  v_add_f32 v16, v16, v18
  v_add_f32 v20, v20, v22
  v_add_f32 v16, v16, v20
  v_add_f32 v24, v24, v25
  v_add_f32 v26, v26, v27
  v_add_f32 v28, v28, v29
  v_add_f32 v30, v30, v31
  v_add_f32 v24, v24, v26
  v_add_f32 v28, v28, v30
  v_add_f32 v24, v24, v28
  v_cvt_pk_bf16_f32 v18, v16, v24
  v_lshlrev_b32 v16, 16, v18
  v_and_b32 v24, 0xffff0000, v18
  v_mul_f32 v18, s44, v16
  v_exp_f32 v18, -v18
  s_nop 0
  v_add_f32 v18, 1.0, v18
  v_rcp_f32 v20, v18
  s_nop 0
  v_mul_f32 v22, v16, v20
  v_mov_b32 v21, v22
  v_fma_f32 v23, -v22, v18, v16
  v_fmac_f32 v22, v23, v20
  v_cmp_class_f32 vcc, v18, s39
  s_nop 1
  v_cndmask_b32 v22, v22, v21, vcc
  v_cvt_pk_bf16_f32 v18, v22, v22
  v_lshlrev_b32 v22, 16, v18
  v_mul_f32 v22, v22, v24
  v_cvt_pk_bf16_f32 v18, v22, v22
  v_and_b32 v18, 0xffff, v18
  s_nop 1
  v_mov_b32_dpp v19, v18 quad_perm:[1,0,3,2] row_mask:0xf bank_mask:0xf
  v_lshl_or_b32 v18, v19, 16, v18
  v_min_u32 v18, 0xfffffffe, v18
  s_mov_b64 exec, s[52:53]
  global_store_dword v6, v18, s[26:27] sc1
  s_mov_b64 exec, -1
  s_branch L_end
L_cdown:
  v_lshrrev_b32 v4, 3, v0
  v_bfe_u32 v5, v0, 2, 1
  v_and_b32 v7, 3, v0
  v_lshlrev_b32 v8, 12, v4
  v_lshlrev_b32 v10, 11, v5
  v_lshlrev_b32 v11, 4, v7
  v_add3_u32 v8, v8, v10, v11
  s_lshl_b32 s33, s50, 2
  s_add_u32 s33, s33, 0x100000
  v_add_u32 v8, s33, v8
  v_lshlrev_b32 v10, 10, v5
  v_lshlrev_b32 v11, 3, v7
  s_lshl_b32 s33, s50, 1
  v_add3_u32 v10, v10, v11, s33
  ds_read_b64 v[40:41], v10 offset:0
  v_lshlrev_b32 v11, 6, v5
  v_lshlrev_b32 v12, 4, v7
  v_add_u32 v11, v11, v12
  s_mov_b32 s46, 4000
L_hy_55:
  global_load_dwordx4 v[16:19], v8, s[26:27] sc1
  s_waitcnt vmcnt(0)
  v_max_u32 v12, v16, v17
  v_max3_u32 v12, v12, v18, v19
  v_cmp_eq_u32 vcc, -1, v12
  s_cbranch_vccz L_hy_done_56
  s_sub_u32 s46, s46, 1
  s_cmp_lg_u32 s46, 0
  s_cbranch_scc1 L_hy_55
L_hy_done_56:
  v_add_f32_dpp v16, v16, v16 row_ror:8 row_mask:0xf bank_mask:0xf
  v_add_f32_dpp v17, v17, v17 row_ror:8 row_mask:0xf bank_mask:0xf
  v_add_f32_dpp v18, v18, v18 row_ror:8 row_mask:0xf bank_mask:0xf
  v_add_f32_dpp v19, v19, v19 row_ror:8 row_mask:0xf bank_mask:0xf
  v_mov_b32 v20, v16
  v_mov_b32 v21, v17
  v_mov_b32 v22, v18
  v_mov_b32 v23, v19
  s_nop 1
  v_permlane16_swap_b32 v16, v20
  v_permlane16_swap_b32 v17, v21
  v_permlane16_swap_b32 v18, v22
  v_permlane16_swap_b32 v19, v23
  v_add_f32 v16, v16, v20
  v_add_f32 v17, v17, v21
  v_add_f32 v18, v18, v22
  v_add_f32 v19, v19, v23
  v_mov_b32 v20, v16
  v_mov_b32 v21, v17
  v_mov_b32 v22, v18
  v_mov_b32 v23, v19
  s_nop 1
  v_permlane32_swap_b32 v16, v20
  v_permlane32_swap_b32 v17, v21
  v_permlane32_swap_b32 v18, v22
  v_permlane32_swap_b32 v19, v23
  v_add_f32 v16, v16, v20
  v_add_f32 v17, v17, v21
  v_add_f32 v18, v18, v22
  v_add_f32 v19, v19, v23
  s_waitcnt lgkmcnt(0)
  v_lshlrev_b32 v36, 16, v40
  v_and_b32 v37, 0xffff0000, v40
  v_lshlrev_b32 v38, 16, v41
  v_and_b32 v39, 0xffff0000, v41
  v_cvt_pk_bf16_f32 v20, v16, v17
  v_lshlrev_b32 v16, 16, v20
  v_and_b32 v17, 0xffff0000, v20
  v_add_f32 v16, v16, v36
  v_add_f32 v17, v17, v37
  v_cvt_pk_bf16_f32 v20, v16, v17
  v_lshlrev_b32 v36, 16, v20
  v_and_b32 v37, 0xffff0000, v20
  v_cvt_pk_bf16_f32 v20, v18, v19
  v_lshlrev_b32 v18, 16, v20
  v_and_b32 v19, 0xffff0000, v20
  v_add_f32 v18, v18, v38
  v_add_f32 v19, v19, v39
  v_cvt_pk_bf16_f32 v20, v18, v19
  v_lshlrev_b32 v38, 16, v20
  v_and_b32 v39, 0xffff0000, v20
  s_barrier
  ds_read_b128 v[48:51], v11 offset:26368
  ds_read_b128 v[52:55], v11 offset:26496
  ds_read_b128 v[56:59], v11 offset:26624
  ds_read_b128 v[60:63], v11 offset:26752
  ds_read_b128 v[64:67], v11 offset:26880
  ds_read_b128 v[68:71], v11 offset:27008
  ds_read_b128 v[72:75], v11 offset:27136
  ds_read_b128 v[76:79], v11 offset:27264
  s_waitcnt lgkmcnt(0)
  v_add_f32 v48, v48, v52
  v_add_f32 v56, v56, v60
  v_add_f32 v64, v64, v68
  v_add_f32 v72, v72, v76
  v_add_f32 v48, v48, v56
  v_add_f32 v64, v64, v72
  v_add_f32 v48, v48, v64
  v_add_f32 v49, v49, v53
  v_add_f32 v57, v57, v61
  v_add_f32 v65, v65, v69
  v_add_f32 v73, v73, v77
  v_add_f32 v49, v49, v57
  v_add_f32 v65, v65, v73
  v_add_f32 v49, v49, v65
  v_add_f32 v50, v50, v54
  v_add_f32 v58, v58, v62
  v_add_f32 v66, v66, v70
  v_add_f32 v74, v74, v78
  v_add_f32 v50, v50, v58
  v_add_f32 v66, v66, v74
  v_add_f32 v50, v50, v66
  v_add_f32 v51, v51, v55
  v_add_f32 v59, v59, v63
  v_add_f32 v67, v67, v71
  v_add_f32 v75, v75, v79
  v_add_f32 v51, v51, v59
  v_add_f32 v67, v67, v75
  v_add_f32 v51, v51, v67
  v_cvt_pk_bf16_f32 v20, v48, v49
  v_lshlrev_b32 v48, 16, v20
  v_and_b32 v49, 0xffff0000, v20
  v_add_f32 v48, v48, v36
  v_add_f32 v49, v49, v37
  v_cvt_pk_bf16_f32 v16, v48, v49
  v_cvt_pk_bf16_f32 v20, v50, v51
  v_lshlrev_b32 v50, 16, v20
  v_and_b32 v51, 0xffff0000, v20
  v_add_f32 v50, v50, v38
  v_add_f32 v51, v51, v39
  v_cvt_pk_bf16_f32 v17, v50, v51
  s_mov_b64 exec, 0xff
  global_store_dwordx2 v10, v[16:17], s[22:23]
  s_mov_b64 exec, -1
L_end:
L_end2:
  s_endpgm
.section .rodata,"a"
.p2align 6
.amdhsa_kernel sequential_preLN__gqa_block_cached__swiglu_ffn__decode_kernel
  .amdhsa_next_free_vgpr 168
  .amdhsa_next_free_sgpr 102
  .amdhsa_accum_offset 168
  .amdhsa_group_segment_fixed_size 0
  .amdhsa_kernarg_size 96
  .amdhsa_user_sgpr_count 2
  .amdhsa_user_sgpr_kernarg_segment_ptr 1
  .amdhsa_system_sgpr_workgroup_id_x 1
.end_amdhsa_kernel
```
